```python
import torch

def _softmax(x, axis=-1):
    return torch.softmax(x, dim=axis)
def _gelu(x):
    return torch.nn.functional.gelu(x, approximate="tanh")
def _silu(x):
    return torch.nn.functional.silu(x)
def _sigmoid(x):
    return torch.sigmoid(x)
def _layernorm(x, axis=-1, eps=1e-5):
    m = x.mean(dim=axis, keepdim=True)
    v = x.var(dim=axis, keepdim=True, unbiased=False)
    return (x - m) / torch.sqrt(v + eps)
def _scatter_add(tgt, idx, src, axis=0):
    return tgt.clone().index_add_(axis, idx, src)
def _segment_sum(src, seg, n):
    out = torch.zeros((n,) + src.shape[1:], dtype=src.dtype)
    return out.index_add_(0, seg, src)
def _pad(x, pw):
    flat = tuple(v for pair in reversed(pw) for v in pair)
    return torch.nn.functional.pad(x, flat)

kernel_name = 'parallel_sum__ssm_conv_s4d__dense_activation_relu__prompt'

def setup_inputs():

    _w = (lambda a: (lambda t: t.to(torch.bfloat16) if t.is_floating_point() else t)(torch.as_tensor(a)))
    def _A_setup():
        Bsz, L, D, N = 1, 2048, 512, 128
        return {
            "u": _w((lambda *s: torch.randn(*s, dtype=torch.bfloat16) * 0.05)(Bsz, L, D)),
            "log_A_real": _w((lambda *s: torch.randn(*s, dtype=torch.bfloat16) * 6.4)(D, N) * 0.5),
            "A_imag": _w((lambda *s: torch.randn(*s, dtype=torch.bfloat16) * 0.1)(D, N) * 3.14),
            "C_real": _w((lambda *s: torch.randn(*s, dtype=torch.bfloat16) * 0.8)(D, N) / N ** 0.5),
            "C_imag": _w((lambda *s: torch.randn(*s, dtype=torch.bfloat16) * 0.8)(D, N) / N ** 0.5),
            "log_dt": _w((lambda *s: torch.randn(*s, dtype=torch.bfloat16) * 0.1)(D) * 0.5 - 4.0),
            "D_skip": _w((lambda *s: torch.randn(*s, dtype=torch.bfloat16) * 0.1)(D)),
        }
    _A_in = _A_setup()

    def _B_setup():
        B, S, D, Dff = 1, 2048, 512, 1376
        return {
            "x": _w((lambda *s: torch.randn(*s, dtype=torch.bfloat16) * 0.05)(B, S, D)),
            "w1": _w((lambda *s: torch.randn(*s, dtype=torch.bfloat16) * 0.05)(D, Dff)),
            "w2": _w((lambda *s: torch.randn(*s, dtype=torch.bfloat16) * 0.05)(Dff, D)),
        }
    _B_in = _B_setup()

    return {
        "A_u": _A_in["u"],
        "A_log_A_real": _A_in["log_A_real"],
        "A_A_imag": _A_in["A_imag"],
        "A_C_real": _A_in["C_real"],
        "A_C_imag": _A_in["C_imag"],
        "A_log_dt": _A_in["log_dt"],
        "A_D_skip": _A_in["D_skip"],
        "B_x": _B_in["x"],
        "B_w1": _B_in["w1"],
        "B_w2": _B_in["w2"],
    }

def reference(A_u, A_log_A_real, A_A_imag, A_C_real, A_C_imag, A_log_dt, A_D_skip, B_x, B_w1, B_w2):
    def _A_ref(u, log_A_real, A_imag, C_real, C_imag, log_dt, D_skip):
        L = u.shape[1]
        dt = torch.exp(log_dt)
        A = -torch.exp(log_A_real) + 1j * A_imag
        C = (C_real + 1j * C_imag) * dt[:, None]
        pos = (lambda x, dt: x.to(dt))(torch.arange(L), log_dt.dtype)
        P = torch.exp((A * dt[:, None])[:, :, None] * pos[None, None, :])
        K = 2.0 * torch.einsum("dn,dnl->dl", C, P).real
        L2 = 2 * L
        u_t = (lambda x, *d: x.permute(*d))(u, 0, 2, 1)
        Kf = (lambda x, *a, **k: torch.fft.rfft(x.float(), *a, **k))(K, L2)
        Uf = (lambda x, *a, **k: torch.fft.rfft(x.float(), *a, **k))(u_t, L2)
        y = (lambda x, *a, **k: torch.fft.irfft(x, *a, **k).to(torch.bfloat16))(Uf * Kf[None, :, :], L2)[:, :, :L]
        y = (lambda x, *d: x.permute(*d))(y, 0, 2, 1)
        return y + u * D_skip[None, None, :]

    def _B_ref(x, w1, w2):
        h = torch.einsum("bsd,df->bsf", x, w1)
        zero = torch.zeros_like(h)
        h = torch.maximum(h, zero)
        return torch.einsum("bsf,fd->bsd", h, w2)

    x = A_u
    xn = _layernorm(x, axis=-1)
    return x + _A_ref(xn, A_log_A_real, A_A_imag, A_C_real, A_C_imag, A_log_dt, A_D_skip) + _B_ref(xn, B_w1, B_w2)
```

```asm
; @launch grid=(512,1,1) block=(256,1,1) lds=81920
.amdgcn_target "amdgcn-amd-amdhsa--gfx950"
.text
.globl parallel_sum__ssm_conv_s4d__dense_activation_relu__prompt_kernel
.p2align 8
.type parallel_sum__ssm_conv_s4d__dense_activation_relu__prompt_kernel,@function
parallel_sum__ssm_conv_s4d__dense_activation_relu__prompt_kernel:
    s_cmp_ge_u32 s2, 512
    s_cbranch_scc1 L_end
    s_load_dwordx16 s[16:31], s[0:1], 0
    s_load_dwordx8 s[32:39], s[0:1], 64
    s_load_dwordx2 s[40:41], s[0:1], 96
    s_cmp_ge_u32 s2, 64
    s_cbranch_scc1 L_notouch
    s_getpc_b64 s[12:13]
L_pc:
    v_lshlrev_b32 v9, 7, v0
    v_min_u32 v9, L_code_end-L_pc-4, v9
    global_load_dword v87, v9, s[12:13]
L_notouch:
    v_lshrrev_b32 v1, 6, v0
    v_and_b32 v2, 63, v0
    v_readfirstlane_b32 s3, v1
    s_and_b32 s4, s2, 7
    s_bfe_u32 s5, s2, 0x50003
    s_cmp_ge_u32 s2, 256
    s_cbranch_scc0 L_ssm
    s_lshr_b32 s6, s4, 1
    s_lshl_b32 s6, s6, 2
    s_lshr_b32 s11, s5, 3
    s_add_u32 s6, s6, s11
    s_and_b32 s7, s4, 1
    s_lshl_b32 s7, s7, 3
    s_and_b32 s10, s5, 7
    s_add_u32 s7, s7, s10
    s_mul_i32 s8, s7, 43
    s_lshr_b32 s8, s8, 4
    s_lshl_b32 s9, s4, 2
    s_add_u32 s9, s9, s11
    v_lshrrev_b32 v3, 4, v2
    v_xor_b32 v3, v3, v2
    v_and_b32 v3, 7, v3
    v_lshrrev_b32 v19, 3, v2
    v_lshlrev_b32 v19, 10, v19
    v_lshl_add_u32 v4, v3, 4, v19
    v_xor_b32 v5, 64, v4
    v_add_u32 v6, 14336, v4
    v_add_u32 v7, 21504, v5
    v_add_u32 v5, 7168, v5
    s_movk_i32 s12, 2560
    v_add_u32 v3, 0, v2
    v_mul_u32_u24 v19, 5462, v3
    v_lshrrev_b32 v19, 16, v19
    v_lshlrev_b32 v3, 4, v2
    v_mad_u32_u24 v8, v19, s12, v3
    v_add_u32 v3, 64, v2
    v_mul_u32_u24 v19, 5462, v3
    v_lshrrev_b32 v19, 16, v19
    v_lshlrev_b32 v3, 4, v2
    v_mad_u32_u24 v9, v19, s12, v3
    v_add_u32 v3, 128, v2
    v_mul_u32_u24 v19, 5462, v3
    v_lshrrev_b32 v19, 16, v19
    v_lshlrev_b32 v3, 4, v2
    v_mad_u32_u24 v10, v19, s12, v3
    s_lshl_b32 s13, s6, 17
    s_lshl_b32 s11, s3, 15
    s_add_u32 s13, s13, s11
    s_mul_i32 s14, s3, 16*2752
    s_lshl_b32 s11, s8, 6
    s_add_u32 s14, s14, s11
    s_lshl_b32 s15, s3, 13
    s_mul_i32 s42, s3, 3072
    s_add_u32 s42, s42, 32768
    s_mov_b32 s43, 0
    s_waitcnt lgkmcnt(0)
    s_mov_b32 s44, s16
    s_mov_b32 s45, s17
    s_mov_b32 s46, 2097152
    s_mov_b32 s47, 0x00020000
    s_mov_b32 s48, s32
    s_mov_b32 s49, s33
    s_mov_b32 s50, 1409024
    s_mov_b32 s51, 0x00020000
    s_mov_b32 s56, s40
    s_mov_b32 s57, s41
    s_mov_b32 s58, 15728640
    s_mov_b32 s59, 0x00020000
    s_setprio 3
    s_add_u32 m0, s15, 0
    s_add_u32 s11, s13, 0
    buffer_load_dwordx4 v4, s[44:47], s11 offen offset:0 lds
    buffer_load_dwordx4 v5, s[44:47], s11 offen offset:1024 lds
    buffer_load_dwordx4 v6, s[44:47], s11 offen offset:2048 lds
    buffer_load_dwordx4 v7, s[44:47], s11 offen offset:3072 lds
    s_add_u32 m0, s42, 0
    s_add_u32 s12, s14, 0
    buffer_load_dwordx4 v8, s[48:51], s12 offen offset:0 lds
    buffer_load_dwordx4 v9, s[48:51], s12 offen offset:1024 lds
    buffer_load_dwordx4 v10, s[48:51], s12 offen offset:2048 lds
    v_mov_b32 v3, 0
    buffer_load_dword v18, v3, s[56:59], 0 offen sc1
    s_setprio 3
    s_add_u32 m0, s15, 4096
    s_add_u32 s11, s13, 128
    buffer_load_dwordx4 v4, s[44:47], s11 offen offset:0 lds
    buffer_load_dwordx4 v5, s[44:47], s11 offen offset:1024 lds
    buffer_load_dwordx4 v6, s[44:47], s11 offen offset:2048 lds
    buffer_load_dwordx4 v7, s[44:47], s11 offen offset:3072 lds
    s_add_u32 m0, s42, 12288
    s_add_u32 s12, s14, 176128
    buffer_load_dwordx4 v8, s[48:51], s12 offen offset:0 lds
    buffer_load_dwordx4 v9, s[48:51], s12 offen offset:1024 lds
    buffer_load_dwordx4 v10, s[48:51], s12 offen offset:2048 lds
    v_and_b32 v3, 31, v2
    v_lshrrev_b32 v19, 5, v2
    v_bfe_u32 v22, v2, 1, 3
    v_xor_b32 v19, v19, v22
    v_lshlrev_b32 v19, 4, v19
    v_lshl_add_u32 v19, v3, 7, v19
    v_add_u32 v11, s15, v19
    v_xor_b32 v12, 32, v11
    v_xor_b32 v13, 64, v11
    v_xor_b32 v14, 96, v11
    v_lshrrev_b32 v3, 5, v2
    v_lshlrev_b32 v3, 3, v3
    v_bfe_u32 v19, v2, 2, 2
    v_add_u32 v3, v3, v19
    v_mul_u32_u24 v3, 192, v3
    v_bfe_u32 v19, v2, 4, 1
    v_lshl_add_u32 v3, v19, 5, v3
    v_and_b32 v19, 3, v2
    v_lshl_add_u32 v3, v19, 3, v3
    v_add_u32 v3, 32768, v3
    s_add_u32 s18, s3, 0
    s_cmp_ge_u32 s18, 3
    s_cselect_b32 s11, 3, 0
    s_sub_u32 s18, s18, s11
    s_lshl_b32 s11, s18, 6
    v_add_u32 v15, s11, v3
    s_add_u32 s19, s3, 1
    s_cmp_ge_u32 s19, 3
    s_cselect_b32 s11, 3, 0
    s_sub_u32 s19, s19, s11
    s_lshl_b32 s11, s19, 6
    v_add_u32 v16, s11, v3
    s_add_u32 s20, s3, 2
    s_cmp_ge_u32 s20, 3
    s_cselect_b32 s11, 3, 0
    s_sub_u32 s20, s20, s11
    s_lshl_b32 s11, s20, 6
    v_add_u32 v17, s11, v3
    v_mov_b32 v196, 0x3f803f80
    v_mov_b32 v80, 0
    v_mov_b32 v81, 0
    s_setprio 3
    s_waitcnt vmcnt(8)
    s_waitcnt lgkmcnt(0)
    s_barrier
    ds_read_b128 v[132:135], v11 offset:0
    ds_read_b128 v[136:139], v12 offset:0
    ds_read_b128 v[140:143], v13 offset:0
    ds_read_b128 v[144:147], v14 offset:0
    ds_read_b64_tr_b16 v[96:97], v15 offset:0
    ds_read_b64_tr_b16 v[98:99], v15 offset:768
    ds_read_b64_tr_b16 v[100:101], v16 offset:0
    ds_read_b64_tr_b16 v[102:103], v16 offset:768
    ds_read_b64_tr_b16 v[104:105], v17 offset:0
    ds_read_b64_tr_b16 v[106:107], v17 offset:768
    ds_read_b64_tr_b16 v[108:109], v15 offset:3072
    ds_read_b64_tr_b16 v[110:111], v15 offset:3840
    ds_read_b64_tr_b16 v[112:113], v16 offset:3072
    ds_read_b64_tr_b16 v[114:115], v16 offset:3840
    ds_read_b64_tr_b16 v[116:117], v17 offset:3072
    ds_read_b64_tr_b16 v[118:119], v17 offset:3840
    s_add_u32 m0, s42, 24576
    s_add_u32 s12, s14, 352256
    buffer_load_dwordx4 v8, s[48:51], s12 offen offset:0 lds
    buffer_load_dwordx4 v9, s[48:51], s12 offen offset:1024 lds
    buffer_load_dwordx4 v10, s[48:51], s12 offen offset:2048 lds
    s_waitcnt lgkmcnt(6)
    v_mfma_f32_32x32x16_bf16 v[32:47], v[96:99], v[132:135], 0
    ds_read_b64_tr_b16 v[120:121], v15 offset:6144
    ds_read_b64_tr_b16 v[122:123], v15 offset:6912
    ds_read_b64_tr_b16 v[124:125], v16 offset:6144
    s_mov_b32 s52, s34
    s_mov_b32 s53, s35
    s_mov_b32 s54, 1409024
    s_mov_b32 s55, 0x00020000
    v_dot2c_f32_bf16 v80, v196, v96
    v_dot2c_f32_bf16 v81, v196, v97
    v_dot2c_f32_bf16 v80, v196, v98
    v_dot2c_f32_bf16 v81, v196, v99
    s_add_u32 m0, s15, 0
    s_add_u32 s11, s13, 256
    buffer_load_dwordx4 v4, s[44:47], s11 offen offset:0 lds
    v_mfma_f32_32x32x16_bf16 v[48:63], v[100:103], v[132:135], 0
    ds_read_b64_tr_b16 v[126:127], v16 offset:6912
    ds_read_b64_tr_b16 v[128:129], v17 offset:6144
    ds_read_b64_tr_b16 v[130:131], v17 offset:6912
    v_lshrrev_b32 v3, 2, v2
    v_and_b32 v3, 4, v3
    v_xor_b32 v3, v3, v2
    v_and_b32 v3, 7, v3
    v_mfma_f32_32x32x16_bf16 v[64:79], v[104:107], v[132:135], 0
    buffer_load_dwordx4 v5, s[44:47], s11 offen offset:1024 lds
    s_waitcnt lgkmcnt(6)
    v_mfma_f32_32x32x16_bf16 v[32:47], v[108:111], v[136:139], v[32:47]
    ds_read_b64_tr_b16 v[96:97], v15 offset:9216
    ds_read_b64_tr_b16 v[98:99], v15 offset:9984
    ds_read_b64_tr_b16 v[100:101], v16 offset:9216
    v_lshrrev_b32 v19, 3, v2
    v_lshlrev_b32 v19, 10, v19
    v_lshl_add_u32 v22, v3, 4, v19
    v_add_u32 v23, 7168, v22
    v_dot2c_f32_bf16 v80, v196, v108
    v_dot2c_f32_bf16 v81, v196, v109
    v_dot2c_f32_bf16 v80, v196, v110
    v_dot2c_f32_bf16 v81, v196, v111
    buffer_load_dwordx4 v6, s[44:47], s11 offen offset:2048 lds
    buffer_load_dwordx4 v7, s[44:47], s11 offen offset:3072 lds
    v_mfma_f32_32x32x16_bf16 v[48:63], v[112:115], v[136:139], v[48:63]
    ds_read_b64_tr_b16 v[102:103], v16 offset:9984
    ds_read_b64_tr_b16 v[104:105], v17 offset:9216
    ds_read_b64_tr_b16 v[106:107], v17 offset:9984
    v_add_u32 v24, 8192, v22
    s_lshr_b32 s68, s5, 3
    s_mul_i32 s21, s68, 88
    s_and_b32 s68, s10, 0
    v_mfma_f32_32x32x16_bf16 v[64:79], v[116:119], v[136:139], v[64:79]
    s_waitcnt lgkmcnt(6)
    v_mfma_f32_32x32x16_bf16 v[32:47], v[120:123], v[140:143], v[32:47]
    v_dot2c_f32_bf16 v80, v196, v120
    v_dot2c_f32_bf16 v81, v196, v121
    v_dot2c_f32_bf16 v80, v196, v122
    v_dot2c_f32_bf16 v81, v196, v123
    s_waitcnt vmcnt(7)
    s_waitcnt lgkmcnt(0)
    s_barrier
    ds_read_b128 v[148:151], v11 offset:4096
    ds_read_b128 v[152:155], v12 offset:4096
    ds_read_b128 v[156:159], v13 offset:4096
    ds_read_b128 v[160:163], v14 offset:4096
    ds_read_b64_tr_b16 v[108:109], v15 offset:12288
    v_mfma_f32_32x32x16_bf16 v[48:63], v[124:127], v[140:143], v[48:63]
    ds_read_b64_tr_b16 v[110:111], v15 offset:13056
    ds_read_b64_tr_b16 v[112:113], v16 offset:12288
    ds_read_b64_tr_b16 v[114:115], v16 offset:13056
    ds_read_b64_tr_b16 v[116:117], v17 offset:12288
    ds_read_b64_tr_b16 v[118:119], v17 offset:13056
    s_add_u32 m0, s42, 0
    s_add_u32 s12, s14, 528384
    buffer_load_dwordx4 v8, s[48:51], s12 offen offset:0 lds
    v_mfma_f32_32x32x16_bf16 v[64:79], v[128:131], v[140:143], v[64:79]
    buffer_load_dwordx4 v9, s[48:51], s12 offen offset:1024 lds
    s_waitcnt lgkmcnt(10)
    v_mfma_f32_32x32x16_bf16 v[32:47], v[96:99], v[144:147], v[32:47]
    ds_read_b64_tr_b16 v[120:121], v15 offset:15360
    ds_read_b64_tr_b16 v[122:123], v15 offset:16128
    ds_read_b64_tr_b16 v[124:125], v16 offset:15360
    s_mul_i32 s68, s68, 0
    s_add_u32 s21, s21, s68
    s_mul_i32 s68, s4, 11
    s_add_u32 s21, s21, s68
    v_dot2c_f32_bf16 v80, v196, v96
    v_dot2c_f32_bf16 v81, v196, v97
    v_dot2c_f32_bf16 v80, v196, v98
    v_dot2c_f32_bf16 v81, v196, v99
    buffer_load_dwordx4 v10, s[48:51], s12 offen offset:2048 lds
    v_mfma_f32_32x32x16_bf16 v[48:63], v[100:103], v[144:147], v[48:63]
    ds_read_b64_tr_b16 v[126:127], v16 offset:16128
    ds_read_b64_tr_b16 v[128:129], v17 offset:15360
    ds_read_b64_tr_b16 v[130:131], v17 offset:16128
    s_lshr_b32 s21, s21, 4
    s_cmp_ge_u32 s21, 22
    s_cselect_b32 s68, 22, 0
    s_sub_u32 s21, s21, s68
    s_mul_i32 s30, s3, 352*1024
    v_mfma_f32_32x32x16_bf16 v[64:79], v[104:107], v[144:147], v[64:79]
    s_waitcnt lgkmcnt(6)
    v_mfma_f32_32x32x16_bf16 v[32:47], v[108:111], v[148:151], v[32:47]
    ds_read_b64_tr_b16 v[96:97], v15 offset:18432
    ds_read_b64_tr_b16 v[98:99], v15 offset:19200
    ds_read_b64_tr_b16 v[100:101], v16 offset:18432
    s_lshl_b32 s68, s10, 7
    s_add_u32 s30, s30, s68
    s_add_u32 s31, s30, 352*1024
    s_lshl_b32 s68, s21, 14
    v_dot2c_f32_bf16 v80, v196, v108
    v_dot2c_f32_bf16 v81, v196, v109
    v_dot2c_f32_bf16 v80, v196, v110
    v_dot2c_f32_bf16 v81, v196, v111
    s_add_u32 m0, s15, 4096
    s_add_u32 s11, s13, 384
    buffer_load_dwordx4 v4, s[44:47], s11 offen offset:0 lds
    v_mfma_f32_32x32x16_bf16 v[48:63], v[112:115], v[148:151], v[48:63]
    ds_read_b64_tr_b16 v[102:103], v16 offset:19200
    ds_read_b64_tr_b16 v[104:105], v17 offset:18432
    ds_read_b64_tr_b16 v[106:107], v17 offset:19200
    s_add_u32 s22, s30, s68
    v_and_b32 v3, 31, v2
    v_bfe_u32 v19, v3, 1, 1
    v_lshlrev_b32 v19, 13, v19
    v_mfma_f32_32x32x16_bf16 v[64:79], v[116:119], v[148:151], v[64:79]
    buffer_load_dwordx4 v5, s[44:47], s11 offen offset:1024 lds
    s_waitcnt lgkmcnt(6)
    v_mfma_f32_32x32x16_bf16 v[32:47], v[120:123], v[152:155], v[32:47]
    ds_read_b64_tr_b16 v[108:109], v15 offset:21504
    ds_read_b64_tr_b16 v[110:111], v15 offset:22272
    ds_read_b64_tr_b16 v[112:113], v16 offset:21504
    v_lshrrev_b32 v30, 2, v3
    v_lshl_add_u32 v19, v30, 4, v19
    v_and_b32 v3, 1, v3
    v_lshl_add_u32 v30, v3, 3, v19
    v_dot2c_f32_bf16 v80, v196, v120
    v_dot2c_f32_bf16 v81, v196, v121
    v_dot2c_f32_bf16 v80, v196, v122
    v_dot2c_f32_bf16 v81, v196, v123
    buffer_load_dwordx4 v6, s[44:47], s11 offen offset:2048 lds
    buffer_load_dwordx4 v7, s[44:47], s11 offen offset:3072 lds
    v_mfma_f32_32x32x16_bf16 v[48:63], v[124:127], v[152:155], v[48:63]
    ds_read_b64_tr_b16 v[114:115], v16 offset:22272
    ds_read_b64_tr_b16 v[116:117], v17 offset:21504
    ds_read_b64_tr_b16 v[118:119], v17 offset:22272
    s_lshl_b32 s23, s6, 2
    s_add_u32 s23, s23, s3
    s_lshl_b32 s23, s23, 7
    s_add_u32 s23, s23, 16384
    v_mfma_f32_32x32x16_bf16 v[64:79], v[128:131], v[152:155], v[64:79]
    s_waitcnt lgkmcnt(6)
    v_mfma_f32_32x32x16_bf16 v[32:47], v[96:99], v[156:159], v[32:47]
    v_dot2c_f32_bf16 v80, v196, v96
    v_dot2c_f32_bf16 v81, v196, v97
    v_dot2c_f32_bf16 v80, v196, v98
    v_dot2c_f32_bf16 v81, v196, v99
    s_waitcnt vmcnt(7)
    s_waitcnt lgkmcnt(0)
    s_barrier
    ds_read_b128 v[132:135], v11 offset:0
    ds_read_b128 v[136:139], v12 offset:0
    ds_read_b128 v[140:143], v13 offset:0
    ds_read_b128 v[144:147], v14 offset:0
    ds_read_b64_tr_b16 v[120:121], v15 offset:24576
    v_mfma_f32_32x32x16_bf16 v[48:63], v[100:103], v[156:159], v[48:63]
    ds_read_b64_tr_b16 v[122:123], v15 offset:25344
    ds_read_b64_tr_b16 v[124:125], v16 offset:24576
    ds_read_b64_tr_b16 v[126:127], v16 offset:25344
    ds_read_b64_tr_b16 v[128:129], v17 offset:24576
    ds_read_b64_tr_b16 v[130:131], v17 offset:25344
    s_add_u32 m0, s42, 12288
    s_add_u32 s12, s14, 704512
    buffer_load_dwordx4 v8, s[48:51], s12 offen offset:0 lds
    v_mfma_f32_32x32x16_bf16 v[64:79], v[104:107], v[156:159], v[64:79]
    buffer_load_dwordx4 v9, s[48:51], s12 offen offset:1024 lds
    s_waitcnt lgkmcnt(10)
    v_mfma_f32_32x32x16_bf16 v[32:47], v[108:111], v[160:163], v[32:47]
    ds_read_b64_tr_b16 v[96:97], v15 offset:27648
    ds_read_b64_tr_b16 v[98:99], v15 offset:28416
    ds_read_b64_tr_b16 v[100:101], v16 offset:27648
    s_lshr_b32 s68, s3, 1
    s_lshl_b32 s24, s6, 1
    s_add_u32 s24, s24, s68
    s_lshl_b32 s25, s24, 7
    v_dot2c_f32_bf16 v80, v196, v108
    v_dot2c_f32_bf16 v81, v196, v109
    v_dot2c_f32_bf16 v80, v196, v110
    v_dot2c_f32_bf16 v81, v196, v111
    buffer_load_dwordx4 v10, s[48:51], s12 offen offset:2048 lds
    v_mfma_f32_32x32x16_bf16 v[48:63], v[112:115], v[160:163], v[48:63]
    ds_read_b64_tr_b16 v[102:103], v16 offset:28416
    ds_read_b64_tr_b16 v[104:105], v17 offset:27648
    ds_read_b64_tr_b16 v[106:107], v17 offset:28416
    s_mul_i32 s24, s24, 176128
    s_and_b32 s68, s3, 1
    s_lshl_b32 s69, s68, 10
    s_add_u32 s24, s24, s69
    v_mfma_f32_32x32x16_bf16 v[64:79], v[116:119], v[160:163], v[64:79]
    s_waitcnt lgkmcnt(6)
    v_mfma_f32_32x32x16_bf16 v[32:47], v[120:123], v[132:135], v[32:47]
    ds_read_b64_tr_b16 v[108:109], v15 offset:30720
    ds_read_b64_tr_b16 v[110:111], v15 offset:31488
    ds_read_b64_tr_b16 v[112:113], v16 offset:30720
    s_lshl_b32 s69, s8, 12
    s_add_u32 s24, s24, s69
    s_add_u32 s24, s24, 9437184
    s_lshl_b32 s25, s6, 7
    v_dot2c_f32_bf16 v80, v196, v120
    v_dot2c_f32_bf16 v81, v196, v121
    v_dot2c_f32_bf16 v80, v196, v122
    v_dot2c_f32_bf16 v81, v196, v123
    s_add_u32 m0, s15, 0
    s_add_u32 s11, s13, 512
    buffer_load_dwordx4 v4, s[44:47], s11 offen offset:0 lds
    v_mfma_f32_32x32x16_bf16 v[48:63], v[124:127], v[132:135], v[48:63]
    ds_read_b64_tr_b16 v[114:115], v16 offset:31488
    ds_read_b64_tr_b16 v[116:117], v17 offset:30720
    ds_read_b64_tr_b16 v[118:119], v17 offset:31488
    s_lshl_b32 s68, s7, 2
    s_add_u32 s25, s25, s68
    s_add_u32 s25, s25, 8192
    s_cmp_eq_u32 s3, 0
    s_cselect_b32 s25, s25, 1073741824
    v_mfma_f32_32x32x16_bf16 v[64:79], v[128:131], v[132:135], v[64:79]
    buffer_load_dwordx4 v5, s[44:47], s11 offen offset:1024 lds
    s_waitcnt lgkmcnt(6)
    v_mfma_f32_32x32x16_bf16 v[32:47], v[96:99], v[136:139], v[32:47]
    ds_read_b64_tr_b16 v[120:121], v15 offset:33792
    ds_read_b64_tr_b16 v[122:123], v15 offset:34560
    ds_read_b64_tr_b16 v[124:125], v16 offset:33792
    s_add_u32 s68, s7, 1
    s_mul_i32 s68, s68, 43
    s_lshr_b32 s68, s68, 4
    s_sub_u32 s0, s68, s8
    v_dot2c_f32_bf16 v80, v196, v96
    v_dot2c_f32_bf16 v81, v196, v97
    v_dot2c_f32_bf16 v80, v196, v98
    v_dot2c_f32_bf16 v81, v196, v99
    buffer_load_dwordx4 v6, s[44:47], s11 offen offset:2048 lds
    buffer_load_dwordx4 v7, s[44:47], s11 offen offset:3072 lds
    v_mfma_f32_32x32x16_bf16 v[48:63], v[100:103], v[136:139], v[48:63]
    ds_read_b64_tr_b16 v[126:127], v16 offset:34560
    ds_read_b64_tr_b16 v[128:129], v17 offset:33792
    ds_read_b64_tr_b16 v[130:131], v17 offset:34560
    v_lshlrev_b32 v31, 4, v2
    v_and_b32 v3, 3, v2
    v_mul_u32_u24 v3, 3072, v3
    v_lshrrev_b32 v19, 5, v2
    v_mfma_f32_32x32x16_bf16 v[64:79], v[104:107], v[136:139], v[64:79]
    s_waitcnt lgkmcnt(6)
    v_mfma_f32_32x32x16_bf16 v[32:47], v[108:111], v[140:143], v[32:47]
    v_dot2c_f32_bf16 v80, v196, v108
    v_dot2c_f32_bf16 v81, v196, v109
    v_dot2c_f32_bf16 v80, v196, v110
    v_dot2c_f32_bf16 v81, v196, v111
    s_waitcnt vmcnt(7)
    s_waitcnt lgkmcnt(0)
    s_barrier
    ds_read_b128 v[148:151], v11 offset:4096
    ds_read_b128 v[152:155], v12 offset:4096
    ds_read_b128 v[156:159], v13 offset:4096
    ds_read_b128 v[160:163], v14 offset:4096
    ds_read_b64_tr_b16 v[96:97], v15 offset:0
    v_mfma_f32_32x32x16_bf16 v[48:63], v[112:115], v[140:143], v[48:63]
    ds_read_b64_tr_b16 v[98:99], v15 offset:768
    ds_read_b64_tr_b16 v[100:101], v16 offset:0
    ds_read_b64_tr_b16 v[102:103], v16 offset:768
    ds_read_b64_tr_b16 v[104:105], v17 offset:0
    ds_read_b64_tr_b16 v[106:107], v17 offset:768
    s_add_u32 m0, s42, 24576
    s_add_u32 s12, s14, 880640
    buffer_load_dwordx4 v8, s[48:51], s12 offen offset:0 lds
    v_mfma_f32_32x32x16_bf16 v[64:79], v[116:119], v[140:143], v[64:79]
    buffer_load_dwordx4 v9, s[48:51], s12 offen offset:1024 lds
    s_waitcnt lgkmcnt(10)
    v_mfma_f32_32x32x16_bf16 v[32:47], v[120:123], v[144:147], v[32:47]
    ds_read_b64_tr_b16 v[108:109], v15 offset:3072
    ds_read_b64_tr_b16 v[110:111], v15 offset:3840
    ds_read_b64_tr_b16 v[112:113], v16 offset:3072
    v_lshl_add_u32 v3, v19, 4, v3
    s_lshl_b32 s68, s18, 7
    s_add_u32 s68, s68, 34816
    v_add_u32 v26, s68, v3
    v_dot2c_f32_bf16 v80, v196, v120
    v_dot2c_f32_bf16 v81, v196, v121
    v_dot2c_f32_bf16 v80, v196, v122
    v_dot2c_f32_bf16 v81, v196, v123
    buffer_load_dwordx4 v10, s[48:51], s12 offen offset:2048 lds
    v_mfma_f32_32x32x16_bf16 v[48:63], v[124:127], v[144:147], v[48:63]
    ds_read_b64_tr_b16 v[114:115], v16 offset:3840
    ds_read_b64_tr_b16 v[116:117], v17 offset:3072
    ds_read_b64_tr_b16 v[118:119], v17 offset:3840
    v_lshlrev_b32 v19, 4, v19
    v_add_u32 v19, s42, v19
    s_lshl_b32 s68, s19, 7
    v_add_u32 v27, s68, v19
    v_mfma_f32_32x32x16_bf16 v[64:79], v[128:131], v[144:147], v[64:79]
    s_waitcnt lgkmcnt(6)
    v_mfma_f32_32x32x16_bf16 v[32:47], v[96:99], v[148:151], v[32:47]
    ds_read_b64_tr_b16 v[120:121], v15 offset:6144
    ds_read_b64_tr_b16 v[122:123], v15 offset:6912
    ds_read_b64_tr_b16 v[124:125], v16 offset:6144
    s_lshl_b32 s68, s20, 7
    v_add_u32 v28, s68, v19
    v_lshlrev_b32 v3, 2, v2
    s_lshl_b32 s68, s18, 8
    v_dot2c_f32_bf16 v80, v196, v96
    v_dot2c_f32_bf16 v81, v196, v97
    v_dot2c_f32_bf16 v80, v196, v98
    v_dot2c_f32_bf16 v81, v196, v99
    s_add_u32 m0, s15, 4096
    s_add_u32 s11, s13, 640
    buffer_load_dwordx4 v4, s[44:47], s11 offen offset:0 lds
    v_mfma_f32_32x32x16_bf16 v[48:63], v[100:103], v[148:151], v[48:63]
    ds_read_b64_tr_b16 v[126:127], v16 offset:6912
    ds_read_b64_tr_b16 v[128:129], v17 offset:6144
    ds_read_b64_tr_b16 v[130:131], v17 offset:6912
    s_add_u32 s68, s68, 34816
    v_add_u32 v26, s68, v3
    s_lshl_b32 s68, s19, 8
    s_add_u32 s68, s68, 34816
    v_mfma_f32_32x32x16_bf16 v[64:79], v[104:107], v[148:151], v[64:79]
    buffer_load_dwordx4 v5, s[44:47], s11 offen offset:1024 lds
    s_waitcnt lgkmcnt(6)
    v_mfma_f32_32x32x16_bf16 v[32:47], v[108:111], v[152:155], v[32:47]
    ds_read_b64_tr_b16 v[96:97], v15 offset:9216
    ds_read_b64_tr_b16 v[98:99], v15 offset:9984
    ds_read_b64_tr_b16 v[100:101], v16 offset:9216
    v_add_u32 v27, s68, v3
    s_lshl_b32 s68, s20, 8
    s_add_u32 s68, s68, 34816
    v_add_u32 v28, s68, v3
    v_dot2c_f32_bf16 v80, v196, v108
    v_dot2c_f32_bf16 v81, v196, v109
    v_dot2c_f32_bf16 v80, v196, v110
    v_dot2c_f32_bf16 v81, v196, v111
    buffer_load_dwordx4 v6, s[44:47], s11 offen offset:2048 lds
    buffer_load_dwordx4 v7, s[44:47], s11 offen offset:3072 lds
    v_mfma_f32_32x32x16_bf16 v[48:63], v[112:115], v[152:155], v[48:63]
    ds_read_b64_tr_b16 v[102:103], v16 offset:9984
    ds_read_b64_tr_b16 v[104:105], v17 offset:9216
    ds_read_b64_tr_b16 v[106:107], v17 offset:9984
    v_mov_b32 v165, 0
    v_mov_b32 v166, 0
    v_mov_b32 v167, 0
    v_mov_b32 v169, 0
    v_mfma_f32_32x32x16_bf16 v[64:79], v[116:119], v[152:155], v[64:79]
    s_waitcnt lgkmcnt(6)
    v_mfma_f32_32x32x16_bf16 v[32:47], v[120:123], v[156:159], v[32:47]
    v_dot2c_f32_bf16 v80, v196, v120
    v_dot2c_f32_bf16 v81, v196, v121
    v_dot2c_f32_bf16 v80, v196, v122
    v_dot2c_f32_bf16 v81, v196, v123
    s_waitcnt vmcnt(7)
    s_waitcnt lgkmcnt(0)
    s_barrier
    ds_read_b128 v[132:135], v11 offset:0
    ds_read_b128 v[136:139], v12 offset:0
    ds_read_b128 v[140:143], v13 offset:0
    ds_read_b128 v[144:147], v14 offset:0
    ds_read_b64_tr_b16 v[108:109], v15 offset:12288
    v_mfma_f32_32x32x16_bf16 v[48:63], v[124:127], v[156:159], v[48:63]
    ds_read_b64_tr_b16 v[110:111], v15 offset:13056
    ds_read_b64_tr_b16 v[112:113], v16 offset:12288
    ds_read_b64_tr_b16 v[114:115], v16 offset:13056
    ds_read_b64_tr_b16 v[116:117], v17 offset:12288
    ds_read_b64_tr_b16 v[118:119], v17 offset:13056
    s_add_u32 m0, s42, 0
    s_add_u32 s12, s14, 1056768
    buffer_load_dwordx4 v8, s[48:51], s12 offen offset:0 lds
    v_mfma_f32_32x32x16_bf16 v[64:79], v[128:131], v[156:159], v[64:79]
    buffer_load_dwordx4 v9, s[48:51], s12 offen offset:1024 lds
    s_waitcnt lgkmcnt(10)
    v_mfma_f32_32x32x16_bf16 v[32:47], v[96:99], v[160:163], v[32:47]
    ds_read_b64_tr_b16 v[120:121], v15 offset:15360
    ds_read_b64_tr_b16 v[122:123], v15 offset:16128
    ds_read_b64_tr_b16 v[124:125], v16 offset:15360
    v_mov_b32 v170, 0
    v_mov_b32 v171, 0
    v_mov_b32 v173, 0
    v_mov_b32 v174, 0
    v_dot2c_f32_bf16 v80, v196, v96
    v_dot2c_f32_bf16 v81, v196, v97
    v_dot2c_f32_bf16 v80, v196, v98
    v_dot2c_f32_bf16 v81, v196, v99
    buffer_load_dwordx4 v10, s[48:51], s12 offen offset:2048 lds
    v_mfma_f32_32x32x16_bf16 v[48:63], v[100:103], v[160:163], v[48:63]
    ds_read_b64_tr_b16 v[126:127], v16 offset:16128
    ds_read_b64_tr_b16 v[128:129], v17 offset:15360
    ds_read_b64_tr_b16 v[130:131], v17 offset:16128
    v_mov_b32 v175, 0
    v_mov_b32 v177, 0
    v_mov_b32 v178, 0
    v_mov_b32 v179, 0
    v_mfma_f32_32x32x16_bf16 v[64:79], v[104:107], v[160:163], v[64:79]
    s_waitcnt lgkmcnt(6)
    v_mfma_f32_32x32x16_bf16 v[32:47], v[108:111], v[132:135], v[32:47]
    ds_read_b64_tr_b16 v[96:97], v15 offset:18432
    ds_read_b64_tr_b16 v[98:99], v15 offset:19200
    ds_read_b64_tr_b16 v[100:101], v16 offset:18432
    s_lshl_b32 s68, s18, 12
    s_add_u32 s68, s68, s24
    s_cmp_ge_u32 s18, s0
    s_cselect_b32 s18, 1073741824, s68
    s_lshl_b32 s68, s19, 12
    v_dot2c_f32_bf16 v80, v196, v108
    v_dot2c_f32_bf16 v81, v196, v109
    v_dot2c_f32_bf16 v80, v196, v110
    v_dot2c_f32_bf16 v81, v196, v111
    s_add_u32 m0, s15, 0
    s_add_u32 s11, s13, 768
    buffer_load_dwordx4 v4, s[44:47], s11 offen offset:0 lds
    v_mfma_f32_32x32x16_bf16 v[48:63], v[112:115], v[132:135], v[48:63]
    ds_read_b64_tr_b16 v[102:103], v16 offset:19200
    ds_read_b64_tr_b16 v[104:105], v17 offset:18432
    ds_read_b64_tr_b16 v[106:107], v17 offset:19200
    s_add_u32 s68, s68, s24
    s_cmp_ge_u32 s19, s0
    s_cselect_b32 s19, 1073741824, s68
    s_lshl_b32 s68, s20, 12
    s_add_u32 s68, s68, s24
    v_mfma_f32_32x32x16_bf16 v[64:79], v[116:119], v[132:135], v[64:79]
    buffer_load_dwordx4 v5, s[44:47], s11 offen offset:1024 lds
    s_waitcnt lgkmcnt(6)
    v_mfma_f32_32x32x16_bf16 v[32:47], v[120:123], v[136:139], v[32:47]
    ds_read_b64_tr_b16 v[108:109], v15 offset:21504
    ds_read_b64_tr_b16 v[110:111], v15 offset:22272
    ds_read_b64_tr_b16 v[112:113], v16 offset:21504
    s_cmp_ge_u32 s20, s0
    s_cselect_b32 s20, 1073741824, s68
    s_and_b32 s26, s3, 1
    s_lshr_b32 s27, s3, 1
    v_lshrrev_b32 v3, 5, v2
    v_dot2c_f32_bf16 v80, v196, v120
    v_dot2c_f32_bf16 v81, v196, v121
    v_dot2c_f32_bf16 v80, v196, v122
    v_dot2c_f32_bf16 v81, v196, v123
    buffer_load_dwordx4 v6, s[44:47], s11 offen offset:2048 lds
    buffer_load_dwordx4 v7, s[44:47], s11 offen offset:3072 lds
    v_mfma_f32_32x32x16_bf16 v[48:63], v[124:127], v[136:139], v[48:63]
    ds_read_b64_tr_b16 v[114:115], v16 offset:22272
    ds_read_b64_tr_b16 v[116:117], v17 offset:21504
    ds_read_b64_tr_b16 v[118:119], v17 offset:22272
    v_lshlrev_b32 v3, 2, v3
    v_bfe_u32 v19, v2, 2, 2
    v_add_u32 v3, v3, v19
    v_lshlrev_b32 v254, 7, v3
    v_mfma_f32_32x32x16_bf16 v[64:79], v[128:131], v[136:139], v[64:79]
    s_waitcnt lgkmcnt(6)
    v_mfma_f32_32x32x16_bf16 v[32:47], v[96:99], v[140:143], v[32:47]
    v_dot2c_f32_bf16 v80, v196, v96
    v_dot2c_f32_bf16 v81, v196, v97
    v_dot2c_f32_bf16 v80, v196, v98
    v_dot2c_f32_bf16 v81, v196, v99
    s_waitcnt vmcnt(7)
    s_waitcnt lgkmcnt(0)
    s_barrier
    ds_read_b128 v[148:151], v11 offset:4096
    ds_read_b128 v[152:155], v12 offset:4096
    ds_read_b128 v[156:159], v13 offset:4096
    ds_read_b128 v[160:163], v14 offset:4096
    ds_read_b64_tr_b16 v[120:121], v15 offset:24576
    v_mfma_f32_32x32x16_bf16 v[48:63], v[100:103], v[140:143], v[48:63]
    ds_read_b64_tr_b16 v[122:123], v15 offset:25344
    ds_read_b64_tr_b16 v[124:125], v16 offset:24576
    ds_read_b64_tr_b16 v[126:127], v16 offset:25344
    ds_read_b64_tr_b16 v[128:129], v17 offset:24576
    ds_read_b64_tr_b16 v[130:131], v17 offset:25344
    s_add_u32 m0, s42, 12288
    s_add_u32 s12, s14, 1232896
    buffer_load_dwordx4 v8, s[48:51], s12 offen offset:0 lds
    v_mfma_f32_32x32x16_bf16 v[64:79], v[104:107], v[140:143], v[64:79]
    buffer_load_dwordx4 v9, s[48:51], s12 offen offset:1024 lds
    s_waitcnt lgkmcnt(10)
    v_mfma_f32_32x32x16_bf16 v[32:47], v[108:111], v[144:147], v[32:47]
    ds_read_b64_tr_b16 v[96:97], v15 offset:27648
    ds_read_b64_tr_b16 v[98:99], v15 offset:28416
    ds_read_b64_tr_b16 v[100:101], v16 offset:27648
    v_bfe_u32 v3, v3, 1, 1
    v_lshl_add_u32 v254, v3, 6, v254
    v_bfe_u32 v3, v2, 4, 1
    v_lshl_add_u32 v254, v3, 5, v254
    v_dot2c_f32_bf16 v80, v196, v108
    v_dot2c_f32_bf16 v81, v196, v109
    v_dot2c_f32_bf16 v80, v196, v110
    v_dot2c_f32_bf16 v81, v196, v111
    buffer_load_dwordx4 v10, s[48:51], s12 offen offset:2048 lds
    v_mfma_f32_32x32x16_bf16 v[48:63], v[112:115], v[144:147], v[48:63]
    ds_read_b64_tr_b16 v[102:103], v16 offset:28416
    ds_read_b64_tr_b16 v[104:105], v17 offset:27648
    ds_read_b64_tr_b16 v[106:107], v17 offset:28416
    v_and_b32 v3, 3, v2
    v_lshl_add_u32 v254, v3, 3, v254
    s_lshl_b32 s68, s26, 6
    v_xor_b32 v255, s68, v254
    v_mfma_f32_32x32x16_bf16 v[64:79], v[116:119], v[144:147], v[64:79]
    s_waitcnt lgkmcnt(6)
    v_mfma_f32_32x32x16_bf16 v[32:47], v[120:123], v[148:151], v[32:47]
    ds_read_b64_tr_b16 v[108:109], v15 offset:30720
    ds_read_b64_tr_b16 v[110:111], v15 offset:31488
    ds_read_b64_tr_b16 v[112:113], v16 offset:30720
    v_xor_b32 v254, 64, v255
    v_add_u32 v248, s42, v254
    v_add_u32 v249, s42, v255
    v_add_u32 v250, s15, v254
    v_dot2c_f32_bf16 v80, v196, v120
    v_dot2c_f32_bf16 v81, v196, v121
    v_dot2c_f32_bf16 v80, v196, v122
    v_dot2c_f32_bf16 v81, v196, v123
    s_add_u32 m0, s15, 4096
    s_add_u32 s11, s13, 896
    buffer_load_dwordx4 v4, s[44:47], s11 offen offset:0 lds
    v_mfma_f32_32x32x16_bf16 v[48:63], v[124:127], v[148:151], v[48:63]
    ds_read_b64_tr_b16 v[114:115], v16 offset:31488
    ds_read_b64_tr_b16 v[116:117], v17 offset:30720
    ds_read_b64_tr_b16 v[118:119], v17 offset:31488
    v_add_u32 v251, s15, v255
    s_lshl_b32 s68, s27, 10
    v_add_u32 v253, s68, v31
    v_xor_b32 v252, 1024, v253
    v_mfma_f32_32x32x16_bf16 v[64:79], v[128:131], v[148:151], v[64:79]
    buffer_load_dwordx4 v5, s[44:47], s11 offen offset:1024 lds
    s_waitcnt lgkmcnt(6)
    v_mfma_f32_32x32x16_bf16 v[32:47], v[96:99], v[152:155], v[32:47]
    ds_read_b64_tr_b16 v[120:121], v15 offset:33792
    ds_read_b64_tr_b16 v[122:123], v15 offset:34560
    ds_read_b64_tr_b16 v[124:125], v16 offset:33792
    s_lshr_b32 s28, s9, 1
    s_lshl_b32 s28, s28, 7
    s_add_u32 s28, s28, 8192
    s_mul_i32 s29, s3, 45056
    v_dot2c_f32_bf16 v80, v196, v96
    v_dot2c_f32_bf16 v81, v196, v97
    v_dot2c_f32_bf16 v80, v196, v98
    v_dot2c_f32_bf16 v81, v196, v99
    buffer_load_dwordx4 v6, s[44:47], s11 offen offset:2048 lds
    buffer_load_dwordx4 v7, s[44:47], s11 offen offset:3072 lds
    v_mfma_f32_32x32x16_bf16 v[48:63], v[100:103], v[152:155], v[48:63]
    ds_read_b64_tr_b16 v[126:127], v16 offset:34560
    ds_read_b64_tr_b16 v[128:129], v17 offset:33792
    ds_read_b64_tr_b16 v[130:131], v17 offset:34560
    s_add_u32 s74, s29, 45056
    s_lshl_b32 s68, s21, 11
    s_add_u32 s75, s29, s68
    s_add_u32 s69, s75, 24576
    v_mfma_f32_32x32x16_bf16 v[64:79], v[104:107], v[152:155], v[64:79]
    buffer_load_dwordx2 v[20:21], v30, s[56:59], s23 offen sc1
    s_waitcnt lgkmcnt(6)
    v_mfma_f32_32x32x16_bf16 v[32:47], v[108:111], v[156:159], v[32:47]
    v_dot2c_f32_bf16 v80, v196, v108
    v_dot2c_f32_bf16 v81, v196, v109
    v_dot2c_f32_bf16 v80, v196, v110
    v_dot2c_f32_bf16 v81, v196, v111
    s_waitcnt vmcnt(8)
    s_waitcnt lgkmcnt(0)
    s_barrier
    ds_read_b128 v[132:135], v11 offset:0
    ds_read_b128 v[136:139], v12 offset:0
    ds_read_b128 v[140:143], v13 offset:0
    ds_read_b128 v[144:147], v14 offset:0
    ds_read_b64_tr_b16 v[96:97], v15 offset:0
    v_mfma_f32_32x32x16_bf16 v[48:63], v[112:115], v[156:159], v[48:63]
    ds_read_b64_tr_b16 v[98:99], v15 offset:768
    ds_read_b64_tr_b16 v[100:101], v16 offset:0
    ds_read_b64_tr_b16 v[102:103], v16 offset:768
    ds_read_b64_tr_b16 v[104:105], v17 offset:0
    ds_read_b64_tr_b16 v[106:107], v17 offset:768
    s_add_u32 m0, s42, 36864
    s_nop 0
    buffer_load_dwordx4 v22, s[52:55], s22 offen lds
    v_mfma_f32_32x32x16_bf16 v[64:79], v[116:119], v[156:159], v[64:79]
    buffer_load_dwordx4 v23, s[52:55], s22 offen offset:1024 lds
    s_add_u32 s22, s22, 16384
    s_cmp_eq_u32 s22, s31
    s_cmov_b32 s22, s30
    s_waitcnt lgkmcnt(10)
    v_mfma_f32_32x32x16_bf16 v[32:47], v[120:123], v[160:163], v[32:47]
    ds_read_b64_tr_b16 v[108:109], v15 offset:3072
    ds_read_b64_tr_b16 v[110:111], v15 offset:3840
    ds_read_b64_tr_b16 v[112:113], v16 offset:3072
    s_cmp_ge_u32 s69, s74
    s_cselect_b32 s68, 45056, 0
    s_sub_u32 s76, s69, s68
    s_mov_b32 s64, s36
    s_mov_b32 s65, s37
    v_dot2c_f32_bf16 v80, v196, v120
    v_dot2c_f32_bf16 v81, v196, v121
    v_dot2c_f32_bf16 v80, v196, v122
    v_dot2c_f32_bf16 v81, v196, v123
    s_add_u32 m0, s42, 38912
    s_nop 0
    buffer_load_dwordx4 v22, s[52:55], s22 offen lds
    v_mfma_f32_32x32x16_bf16 v[48:63], v[124:127], v[160:163], v[48:63]
    ds_read_b64_tr_b16 v[114:115], v16 offset:3840
    ds_read_b64_tr_b16 v[116:117], v17 offset:3072
    ds_read_b64_tr_b16 v[118:119], v17 offset:3840
    s_mov_b32 s66, 2097152
    s_mov_b32 s67, 0x00020000
    s_mul_i32 s68, s9, 176128
    s_add_u32 s68, s68, 9437184
    v_mfma_f32_32x32x16_bf16 v[64:79], v[128:131], v[160:163], v[64:79]
    s_waitcnt lgkmcnt(6)
    v_mfma_f32_32x32x16_bf16 v[32:47], v[96:99], v[132:135], v[32:47]
    ds_read_b64_tr_b16 v[120:121], v15 offset:6144
    ds_read_b64_tr_b16 v[122:123], v15 offset:6912
    ds_read_b64_tr_b16 v[124:125], v16 offset:6144
    s_add_u32 s60, s40, s68
    s_addc_u32 s61, s41, 0
    s_mov_b32 s62, 176128
    s_mov_b32 s63, 0x00020000
    v_dot2c_f32_bf16 v80, v196, v96
    v_dot2c_f32_bf16 v81, v196, v97
    v_dot2c_f32_bf16 v80, v196, v98
    v_dot2c_f32_bf16 v81, v196, v99
    v_mfma_f32_32x32x16_bf16 v[48:63], v[100:103], v[132:135], v[48:63]
    ds_read_b64_tr_b16 v[126:127], v16 offset:6912
    ds_read_b64_tr_b16 v[128:129], v17 offset:6144
    ds_read_b64_tr_b16 v[130:131], v17 offset:6912
    v_mfma_f32_32x32x16_bf16 v[64:79], v[104:107], v[132:135], v[64:79]
    s_waitcnt lgkmcnt(6)
    v_mfma_f32_32x32x16_bf16 v[32:47], v[108:111], v[136:139], v[32:47]
    ds_read_b64_tr_b16 v[96:97], v15 offset:9216
    ds_read_b64_tr_b16 v[98:99], v15 offset:9984
    ds_read_b64_tr_b16 v[100:101], v16 offset:9216
    v_dot2c_f32_bf16 v80, v196, v108
    v_dot2c_f32_bf16 v81, v196, v109
    v_dot2c_f32_bf16 v80, v196, v110
    v_dot2c_f32_bf16 v81, v196, v111
    v_mfma_f32_32x32x16_bf16 v[48:63], v[112:115], v[136:139], v[48:63]
    ds_read_b64_tr_b16 v[102:103], v16 offset:9984
    ds_read_b64_tr_b16 v[104:105], v17 offset:9216
    ds_read_b64_tr_b16 v[106:107], v17 offset:9984
    v_mfma_f32_32x32x16_bf16 v[64:79], v[116:119], v[136:139], v[64:79]
    s_waitcnt lgkmcnt(6)
    v_mfma_f32_32x32x16_bf16 v[32:47], v[120:123], v[140:143], v[32:47]
    v_dot2c_f32_bf16 v80, v196, v120
    v_dot2c_f32_bf16 v81, v196, v121
    v_dot2c_f32_bf16 v80, v196, v122
    v_dot2c_f32_bf16 v81, v196, v123
    s_waitcnt vmcnt(4)
    s_waitcnt lgkmcnt(0)
    s_barrier
    ds_read_b128 v[148:151], v11 offset:4096
    ds_read_b128 v[152:155], v12 offset:4096
    ds_read_b128 v[156:159], v13 offset:4096
    ds_read_b128 v[160:163], v14 offset:4096
    ds_read_b64_tr_b16 v[108:109], v15 offset:12288
    v_mfma_f32_32x32x16_bf16 v[48:63], v[124:127], v[140:143], v[48:63]
    ds_read_b64_tr_b16 v[110:111], v15 offset:13056
    ds_read_b64_tr_b16 v[112:113], v16 offset:12288
    ds_read_b64_tr_b16 v[114:115], v16 offset:13056
    ds_read_b64_tr_b16 v[116:117], v17 offset:12288
    ds_read_b64_tr_b16 v[118:119], v17 offset:13056
    s_add_u32 m0, s42, 24576
    s_nop 0
    buffer_load_dwordx4 v24, s[52:55], s22 offen lds
    s_add_u32 s22, s22, 16384
    s_cmp_eq_u32 s22, s31
    s_cmov_b32 s22, s30
    v_mfma_f32_32x32x16_bf16 v[64:79], v[128:131], v[140:143], v[64:79]
    s_add_u32 m0, s42, 25600
    s_nop 0
    buffer_load_dwordx4 v22, s[52:55], s22 offen lds
    s_waitcnt lgkmcnt(10)
    v_mfma_f32_32x32x16_bf16 v[32:47], v[96:99], v[144:147], v[32:47]
    ds_read_b64_tr_b16 v[120:121], v15 offset:15360
    ds_read_b64_tr_b16 v[122:123], v15 offset:16128
    ds_read_b64_tr_b16 v[124:125], v16 offset:15360
    v_dot2c_f32_bf16 v80, v196, v96
    v_dot2c_f32_bf16 v81, v196, v97
    v_dot2c_f32_bf16 v80, v196, v98
    v_dot2c_f32_bf16 v81, v196, v99
    buffer_load_dwordx4 v23, s[52:55], s22 offen offset:1024 lds
    s_add_u32 s22, s22, 16384
    s_cmp_eq_u32 s22, s31
    s_cmov_b32 s22, s30
    v_mfma_f32_32x32x16_bf16 v[48:63], v[100:103], v[144:147], v[48:63]
    ds_read_b64_tr_b16 v[126:127], v16 offset:16128
    ds_read_b64_tr_b16 v[128:129], v17 offset:15360
    ds_read_b64_tr_b16 v[130:131], v17 offset:16128
    v_mfma_f32_32x32x16_bf16 v[64:79], v[104:107], v[144:147], v[64:79]
    s_add_u32 m0, s15, 0
    s_nop 0
    buffer_load_dwordx4 v22, s[52:55], s22 offen lds
    s_waitcnt lgkmcnt(6)
    v_mfma_f32_32x32x16_bf16 v[32:47], v[108:111], v[148:151], v[32:47]
    ds_read_b64_tr_b16 v[96:97], v15 offset:18432
    ds_read_b64_tr_b16 v[98:99], v15 offset:19200
    ds_read_b64_tr_b16 v[100:101], v16 offset:18432
    v_dot2c_f32_bf16 v80, v196, v108
    v_dot2c_f32_bf16 v81, v196, v109
    v_dot2c_f32_bf16 v80, v196, v110
    v_dot2c_f32_bf16 v81, v196, v111
    buffer_load_dwordx4 v23, s[52:55], s22 offen offset:1024 lds
    s_add_u32 s22, s22, 16384
    s_cmp_eq_u32 s22, s31
    s_cmov_b32 s22, s30
    v_mfma_f32_32x32x16_bf16 v[48:63], v[112:115], v[148:151], v[48:63]
    ds_read_b64_tr_b16 v[102:103], v16 offset:19200
    ds_read_b64_tr_b16 v[104:105], v17 offset:18432
    ds_read_b64_tr_b16 v[106:107], v17 offset:19200
    v_mfma_f32_32x32x16_bf16 v[64:79], v[116:119], v[148:151], v[64:79]
    s_add_u32 m0, s15, 2048
    s_nop 0
    buffer_load_dwordx4 v22, s[52:55], s22 offen lds
    s_waitcnt lgkmcnt(6)
    v_mfma_f32_32x32x16_bf16 v[32:47], v[120:123], v[152:155], v[32:47]
    ds_read_b64_tr_b16 v[108:109], v15 offset:21504
    ds_read_b64_tr_b16 v[110:111], v15 offset:22272
    ds_read_b64_tr_b16 v[112:113], v16 offset:21504
    v_dot2c_f32_bf16 v80, v196, v120
    v_dot2c_f32_bf16 v81, v196, v121
    v_dot2c_f32_bf16 v80, v196, v122
    v_dot2c_f32_bf16 v81, v196, v123
    v_mfma_f32_32x32x16_bf16 v[48:63], v[124:127], v[152:155], v[48:63]
    ds_read_b64_tr_b16 v[114:115], v16 offset:22272
    ds_read_b64_tr_b16 v[116:117], v17 offset:21504
    ds_read_b64_tr_b16 v[118:119], v17 offset:22272
    v_mfma_f32_32x32x16_bf16 v[64:79], v[128:131], v[152:155], v[64:79]
    s_waitcnt lgkmcnt(6)
    v_dot2c_f32_bf16 v80, v196, v96
    v_dot2c_f32_bf16 v81, v196, v97
    v_dot2c_f32_bf16 v80, v196, v98
    v_dot2c_f32_bf16 v81, v196, v99
    v_mfma_f32_32x32x16_bf16 v[32:47], v[96:99], v[156:159], v[32:47]
    s_waitcnt vmcnt(9)
    v_add_u32 v18, 2654435769, v18
    v_cmp_ne_u32 vcc, v21, v18
    s_nop 0
    s_cbranch_vccnz L_slow0
L_ret0:
    v_lshlrev_b32 v20, 16, v20
    v_xor_b32 v20, 0x80000000, v20
    v_cvt_pk_bf16_f32 v176, v20, v20
    v_mfma_f32_32x32x16_bf16 v[48:63], v[100:103], v[156:159], v[48:63]
    s_waitcnt lgkmcnt(0)
    v_dot2c_f32_bf16 v80, v196, v108
    v_dot2c_f32_bf16 v81, v196, v109
    v_dot2c_f32_bf16 v80, v196, v110
    v_dot2c_f32_bf16 v81, v196, v111
    v_mfma_f32_32x32x16_bf16 v[64:79], v[104:107], v[156:159], v[64:79]
    v_mfma_f32_32x32x16_bf16 v[32:47], v[108:111], v[160:163], v[32:47]
    s_nop 0
    v_add_f32 v80, v80, v81
    v_cvt_pk_bf16_f32 v81, v80, v80
    v_and_b32 v81, 0xffff0000, v81
    v_sub_f32 v82, v80, v81
    v_cvt_pk_bf16_f32 v164, v81, v82
    ds_write_b32 v26, v164
    v_mfma_f32_32x32x16_bf16 v[48:63], v[112:115], v[160:163], v[48:63]
    v_mfma_f32_32x32x16_bf16 v[64:79], v[116:119], v[160:163], v[64:79]
    s_waitcnt lgkmcnt(0)
    s_barrier
    ds_read_b32 v168, v27
    ds_read_b32 v172, v28
    v_mfma_f32_32x32x16_bf16 v[32:47], v[164:167], v[176:179], v[32:47]
    s_waitcnt lgkmcnt(0)
    v_mfma_f32_32x32x16_bf16 v[48:63], v[168:171], v[176:179], v[48:63]
    v_mfma_f32_32x32x16_bf16 v[64:79], v[172:175], v[176:179], v[64:79]
    s_nop 8
    v_cvt_pk_bf16_f32 v96, v32, v33
    v_cvt_pk_bf16_f32 v97, v34, v35
    v_cvt_pk_bf16_f32 v98, v36, v37
    v_cvt_pk_bf16_f32 v99, v38, v39
    v_cvt_pk_bf16_f32 v100, v40, v41
    v_cvt_pk_bf16_f32 v101, v42, v43
    v_cvt_pk_bf16_f32 v102, v44, v45
    v_cvt_pk_bf16_f32 v103, v46, v47
    v_pk_max_i16 v96, v96, 0
    v_pk_max_i16 v97, v97, 0
    v_pk_max_i16 v98, v98, 0
    v_pk_max_i16 v99, v99, 0
    v_pk_max_i16 v100, v100, 0
    v_pk_max_i16 v101, v101, 0
    v_pk_max_i16 v102, v102, 0
    v_pk_max_i16 v103, v103, 0
    buffer_store_dwordx4 v[96:99], v31, s[56:59], s18 offen offset:0 sc1
    buffer_store_dwordx4 v[100:103], v31, s[56:59], s18 offen offset:2048 sc1
    s_waitcnt lgkmcnt(0)
    v_cvt_pk_bf16_f32 v104, v48, v49
    v_cvt_pk_bf16_f32 v105, v50, v51
    v_cvt_pk_bf16_f32 v106, v52, v53
    v_cvt_pk_bf16_f32 v107, v54, v55
    v_cvt_pk_bf16_f32 v108, v56, v57
    v_cvt_pk_bf16_f32 v109, v58, v59
    v_cvt_pk_bf16_f32 v110, v60, v61
    v_cvt_pk_bf16_f32 v111, v62, v63
    v_pk_max_i16 v104, v104, 0
    v_pk_max_i16 v105, v105, 0
    v_pk_max_i16 v106, v106, 0
    v_pk_max_i16 v107, v107, 0
    v_pk_max_i16 v108, v108, 0
    v_pk_max_i16 v109, v109, 0
    v_pk_max_i16 v110, v110, 0
    v_pk_max_i16 v111, v111, 0
    buffer_store_dwordx4 v[104:107], v31, s[56:59], s19 offen offset:0 sc1
    buffer_store_dwordx4 v[108:111], v31, s[56:59], s19 offen offset:2048 sc1
    v_cvt_pk_bf16_f32 v112, v64, v65
    v_cvt_pk_bf16_f32 v113, v66, v67
    v_cvt_pk_bf16_f32 v114, v68, v69
    v_cvt_pk_bf16_f32 v115, v70, v71
    v_cvt_pk_bf16_f32 v116, v72, v73
    v_cvt_pk_bf16_f32 v117, v74, v75
    v_cvt_pk_bf16_f32 v118, v76, v77
    v_cvt_pk_bf16_f32 v119, v78, v79
    v_pk_max_i16 v112, v112, 0
    v_pk_max_i16 v113, v113, 0
    v_pk_max_i16 v114, v114, 0
    v_pk_max_i16 v115, v115, 0
    v_pk_max_i16 v116, v116, 0
    v_pk_max_i16 v117, v117, 0
    v_pk_max_i16 v118, v118, 0
    v_pk_max_i16 v119, v119, 0
    buffer_store_dwordx4 v[112:115], v31, s[56:59], s20 offen offset:0 sc1
    buffer_store_dwordx4 v[116:119], v31, s[56:59], s20 offen offset:2048 sc1
    v_readfirstlane_b32 s13, v18
    s_mov_b32 s18, s76
    s_mov_b32 s19, s75
    s_mov_b32 s20, s74
    s_add_u32 m0, s15, 3072
    s_nop 0
    buffer_load_dwordx4 v24, s[52:55], s22 offen lds
    s_add_u32 s22, s22, 16384
    s_cmp_eq_u32 s22, s31
    s_cmov_b32 s22, s30
    s_add_u32 m0, s42, 0
    s_nop 0
    buffer_load_dwordx4 v22, s[52:55], s22 offen lds
    buffer_load_dwordx4 v23, s[52:55], s22 offen offset:1024 lds
    s_add_u32 s22, s22, 16384
    s_cmp_eq_u32 s22, s31
    s_cmov_b32 s22, s30
    s_add_u32 m0, s15, 4096
    s_nop 0
    buffer_load_dwordx4 v22, s[52:55], s22 offen lds
    buffer_load_dwordx4 v23, s[52:55], s22 offen offset:1024 lds
    s_add_u32 s22, s22, 16384
    s_cmp_eq_u32 s22, s31
    s_cmov_b32 s22, s30
    s_add_u32 m0, s15, 6144
    s_nop 0
    buffer_load_dwordx4 v22, s[52:55], s22 offen lds
    buffer_load_dwordx4 v23, s[52:55], s22 offen offset:1024 lds
    s_add_u32 s22, s22, 16384
    s_cmp_eq_u32 s22, s31
    s_cmov_b32 s22, s30
    s_add_u32 m0, s42, 12288
    s_nop 0
    buffer_load_dwordx4 v22, s[52:55], s22 offen lds
    s_waitcnt vmcnt(15)
    ds_read_b64_tr_b16 v[96:97], v248 offset:36864
    ds_read_b64_tr_b16 v[100:101], v249 offset:36864
    ds_read_b64_tr_b16 v[98:99], v248 offset:37888
    ds_read_b64_tr_b16 v[102:103], v249 offset:37888
    ds_read_b64_tr_b16 v[104:105], v248 offset:38912
    ds_read_b64_tr_b16 v[108:109], v249 offset:38912
    ds_read_b64_tr_b16 v[106:107], v248 offset:24576
    ds_read_b64_tr_b16 v[110:111], v249 offset:24576
    ds_read_b64_tr_b16 v[112:113], v248 offset:25600
    ds_read_b64_tr_b16 v[116:117], v249 offset:25600
    ds_read_b64_tr_b16 v[114:115], v248 offset:26624
    ds_read_b64_tr_b16 v[118:119], v249 offset:26624
    ds_read_b64_tr_b16 v[120:121], v250 offset:0
    ds_read_b64_tr_b16 v[124:125], v251 offset:0
    ds_read_b64_tr_b16 v[122:123], v250 offset:1024
    ds_read_b64_tr_b16 v[126:127], v251 offset:1024
    s_waitcnt vmcnt(8)
    s_barrier
    v_mov_b32 v3, 0
    s_mov_b64 exec, 1
    buffer_store_dword v18, v3, s[56:59], s25 offen sc1
    s_mov_b64 exec, -1
    s_waitcnt lgkmcnt(0)
    s_add_u32 m0, s42, 13312
    s_nop 0
    buffer_load_dwordx4 v24, s[52:55], s22 offen lds
    s_add_u32 s22, s22, 16384
    s_cmp_eq_u32 s22, s31
    s_cmov_b32 s22, s30
    s_add_u32 m0, s42, 14336
    s_nop 0
    buffer_load_dwordx4 v22, s[52:55], s22 offen lds
    s_add_u32 m0, s42, 2048
    s_nop 0
    buffer_load_dwordx4 v24, s[52:55], s22 offen lds
    s_add_u32 s22, s22, 16384
    s_cmp_eq_u32 s22, s31
    s_cmov_b32 s22, s30
    s_add_u32 m0, s42, 36864
    s_nop 0
    buffer_load_dwordx4 v22, s[52:55], s22 offen lds
    buffer_load_dwordx4 v23, s[52:55], s22 offen offset:1024 lds
    s_add_u32 s22, s22, 16384
    s_cmp_eq_u32 s22, s31
    s_cmov_b32 s22, s30
    s_add_u32 m0, s42, 38912
    s_nop 0
    buffer_load_dwordx4 v22, s[52:55], s22 offen lds
    s_add_u32 m0, s42, 24576
    s_nop 0
    buffer_load_dwordx4 v24, s[52:55], s22 offen lds
    s_add_u32 s22, s22, 16384
    s_cmp_eq_u32 s22, s31
    s_cmov_b32 s22, s30
    s_add_u32 m0, s42, 25600
    s_nop 0
    buffer_load_dwordx4 v22, s[52:55], s22 offen lds
    buffer_load_dwordx4 v23, s[52:55], s22 offen offset:1024 lds
    s_add_u32 s22, s22, 16384
    s_cmp_eq_u32 s22, s31
    s_cmov_b32 s22, s30
    s_add_u32 m0, s15, 0
    s_nop 0
    buffer_load_dwordx4 v22, s[52:55], s22 offen lds
    buffer_load_dwordx4 v23, s[52:55], s22 offen offset:1024 lds
    s_add_u32 s22, s22, 16384
    s_cmp_eq_u32 s22, s31
    s_cmov_b32 s22, s30
    s_waitcnt vmcnt(17)
    ds_read_b64_tr_b16 v[128:129], v250 offset:2048
    ds_read_b64_tr_b16 v[132:133], v251 offset:2048
    ds_read_b64_tr_b16 v[130:131], v250 offset:3072
    ds_read_b64_tr_b16 v[134:135], v251 offset:3072
    ds_read_b64_tr_b16 v[136:137], v248 offset:0
    ds_read_b64_tr_b16 v[140:141], v249 offset:0
    ds_read_b64_tr_b16 v[138:139], v248 offset:1024
    ds_read_b64_tr_b16 v[142:143], v249 offset:1024
    s_waitcnt lgkmcnt(0)
    s_add_u32 m0, s15, 2048
    s_nop 0
    buffer_load_dwordx4 v22, s[52:55], s22 offen lds
    buffer_load_dwordx4 v23, s[52:55], s22 offen offset:1024 lds
    s_add_u32 s22, s22, 16384
    s_cmp_eq_u32 s22, s31
    s_cmov_b32 s22, s30
    s_add_u32 m0, s42, 0
    s_nop 0
    buffer_load_dwordx4 v22, s[52:55], s22 offen lds
    buffer_load_dwordx4 v23, s[52:55], s22 offen offset:1024 lds
    s_add_u32 s22, s22, 16384
    s_cmp_eq_u32 s22, s31
    s_cmov_b32 s22, s30
    s_waitcnt vmcnt(17)
    ds_read_b64_tr_b16 v[144:145], v250 offset:4096
    ds_read_b64_tr_b16 v[148:149], v251 offset:4096
    ds_read_b64_tr_b16 v[146:147], v250 offset:5120
    ds_read_b64_tr_b16 v[150:151], v251 offset:5120
    ds_read_b64_tr_b16 v[152:153], v250 offset:6144
    ds_read_b64_tr_b16 v[156:157], v251 offset:6144
    ds_read_b64_tr_b16 v[154:155], v250 offset:7168
    ds_read_b64_tr_b16 v[158:159], v251 offset:7168
    s_waitcnt lgkmcnt(0)
    s_add_u32 m0, s15, 4096
    s_nop 0
    buffer_load_dwordx4 v22, s[52:55], s22 offen lds
    buffer_load_dwordx4 v23, s[52:55], s22 offen offset:1024 lds
    s_add_u32 s22, s22, 16384
    s_cmp_eq_u32 s22, s31
    s_cmov_b32 s22, s30
    s_add_u32 m0, s15, 6144
    s_nop 0
    buffer_load_dwordx4 v22, s[52:55], s22 offen lds
    buffer_load_dwordx4 v23, s[52:55], s22 offen offset:1024 lds
    s_add_u32 s22, s22, 16384
    s_cmp_eq_u32 s22, s31
    s_cmov_b32 s22, s30
    s_waitcnt vmcnt(16)
    ds_read_b64_tr_b16 v[160:161], v248 offset:12288
    ds_read_b64_tr_b16 v[164:165], v249 offset:12288
    ds_read_b64_tr_b16 v[162:163], v248 offset:13312
    ds_read_b64_tr_b16 v[166:167], v249 offset:13312
    ds_read_b64_tr_b16 v[168:169], v248 offset:14336
    ds_read_b64_tr_b16 v[172:173], v249 offset:14336
    ds_read_b64_tr_b16 v[170:171], v248 offset:2048
    ds_read_b64_tr_b16 v[174:175], v249 offset:2048
    s_waitcnt lgkmcnt(0)
    s_add_u32 m0, s42, 12288
    s_nop 0
    buffer_load_dwordx4 v22, s[52:55], s22 offen lds
    buffer_load_dwordx4 v23, s[52:55], s22 offen offset:1024 lds
    s_add_u32 s22, s22, 16384
    s_cmp_eq_u32 s22, s31
    s_cmov_b32 s22, s30
    s_add_u32 m0, s42, 14336
    s_nop 0
    buffer_load_dwordx4 v22, s[52:55], s22 offen lds
    s_add_u32 m0, s42, 2048
    s_nop 0
    buffer_load_dwordx4 v24, s[52:55], s22 offen lds
    s_add_u32 s22, s22, 16384
    s_cmp_eq_u32 s22, s31
    s_cmov_b32 s22, s30
    s_waitcnt vmcnt(16)
    ds_read_b64_tr_b16 v[176:177], v248 offset:36864
    ds_read_b64_tr_b16 v[180:181], v249 offset:36864
    ds_read_b64_tr_b16 v[178:179], v248 offset:37888
    ds_read_b64_tr_b16 v[182:183], v249 offset:37888
    ds_read_b64_tr_b16 v[184:185], v248 offset:38912
    ds_read_b64_tr_b16 v[188:189], v249 offset:38912
    ds_read_b64_tr_b16 v[186:187], v248 offset:24576
    ds_read_b64_tr_b16 v[190:191], v249 offset:24576
    s_waitcnt lgkmcnt(0)
    s_cmp_lg_u32 s3, 0
    s_cbranch_scc1 L_nhp
    s_load_dwordx16 s[68:83], s[40:41], s28 glc
L_nhp:
    s_add_u32 m0, s42, 36864
    s_nop 0
    buffer_load_dwordx4 v22, s[52:55], s22 offen lds
    buffer_load_dwordx4 v23, s[52:55], s22 offen offset:1024 lds
    s_add_u32 s22, s22, 16384
    s_cmp_eq_u32 s22, s31
    s_cmov_b32 s22, s30
    s_add_u32 m0, s42, 38912
    s_nop 0
    buffer_load_dwordx4 v22, s[52:55], s22 offen lds
    s_add_u32 m0, s42, 24576
    s_nop 0
    buffer_load_dwordx4 v24, s[52:55], s22 offen lds
    s_add_u32 s22, s22, 16384
    s_cmp_eq_u32 s22, s31
    s_cmov_b32 s22, s30
    s_cmp_lg_u32 s3, 0
    s_cbranch_scc1 L_hok
    s_waitcnt lgkmcnt(0)
    s_mov_b64 vcc, s[68:69]
    s_or_b64 vcc, vcc, s[70:71]
    s_and_b64 s[68:69], s[68:69], s[70:71]
    s_or_b64 vcc, vcc, s[72:73]
    s_and_b64 s[68:69], s[68:69], s[72:73]
    s_or_b64 vcc, vcc, s[74:75]
    s_and_b64 s[68:69], s[68:69], s[74:75]
    s_or_b64 vcc, vcc, s[76:77]
    s_and_b64 s[68:69], s[68:69], s[76:77]
    s_or_b64 vcc, vcc, s[78:79]
    s_and_b64 s[68:69], s[68:69], s[78:79]
    s_or_b64 vcc, vcc, s[80:81]
    s_and_b64 s[68:69], s[68:69], s[80:81]
    s_or_b64 vcc, vcc, s[82:83]
    s_and_b64 s[68:69], s[68:69], s[82:83]
    s_or_b32 vcc_lo, vcc_lo, vcc_hi
    s_and_b32 s68, s68, s69
    s_xor_b32 vcc_lo, vcc_lo, s13
    s_xor_b32 s68, s68, s13
    s_or_b32 s68, s68, vcc_lo
    s_cbranch_scc1 L_slow1
L_ret1:
L_hok:
    s_barrier
    s_setprio 1
    s_mov_b32 s12, s18
    buffer_load_dwordx4 v[192:195], v252, s[60:63], s12 offen sc1
    buffer_load_dwordx4 v[196:199], v253, s[60:63], s12 offen sc1
    s_add_u32 s12, s12, 2048
    s_cmp_eq_u32 s12, s20
    s_cmov_b32 s12, s29
    buffer_load_dwordx4 v[200:203], v252, s[60:63], s12 offen sc1
    buffer_load_dwordx4 v[204:207], v253, s[60:63], s12 offen sc1
    s_add_u32 s12, s12, 2048
    s_cmp_eq_u32 s12, s20
    s_cmov_b32 s12, s29
    buffer_load_dwordx4 v[208:211], v252, s[60:63], s12 offen sc1
    buffer_load_dwordx4 v[212:215], v253, s[60:63], s12 offen sc1
    s_add_u32 s12, s12, 2048
    s_cmp_eq_u32 s12, s20
    s_cmov_b32 s12, s29
    buffer_load_dwordx4 v[216:219], v252, s[60:63], s12 offen sc1
    buffer_load_dwordx4 v[220:223], v253, s[60:63], s12 offen sc1
    s_add_u32 s12, s12, 2048
    s_cmp_eq_u32 s12, s20
    s_cmov_b32 s12, s29
    buffer_load_dwordx4 v[224:227], v252, s[60:63], s12 offen sc1
    buffer_load_dwordx4 v[228:231], v253, s[60:63], s12 offen sc1
    v_and_b32 v3, 31, v2
    v_lshrrev_b32 v19, 5, v2
    v_lshlrev_b32 v14, 14, v19
    v_lshl_add_u32 v14, v3, 2, v14
    s_lshl_b32 s11, s10, 1
    s_add_u32 s11, s11, s26
    s_lshl_b32 s6, s11, 17
    s_lshl_b32 s7, s9, 1
    s_add_u32 s7, s7, s27
    s_lshl_b32 s11, s7, 7
    s_add_u32 s6, s6, s11
    s_add_u32 s6, s6, 5242880
    s_lshl_b32 s8, s10, 2
    s_lshr_b32 s0, s9, 3
    s_add_u32 s8, s8, s0
    s_lshl_b32 s8, s8, 1
    s_add_u32 s8, s8, s26
    s_lshl_b32 s8, s8, 6
    s_add_u32 s8, s8, 12288
    s_add_u32 s23, s11, 16384
    s_xor_b32 s11, s3, 3
    s_lshl_b32 s11, s11, 13
    v_add_u32 v17, s11, v31
    s_xor_b32 s11, s3, 2
    s_lshl_b32 s11, s11, 13
    v_add_u32 v20, s11, v31
    s_xor_b32 s11, s3, 1
    s_mul_i32 s11, s11, 3072
    v_add_u32 v21, s11, v31
    v_add_u32 v28, s42, v31
    v_add_u32 v29, s15, v31
    v_bfe_u32 v26, v3, 1, 2
    v_lshlrev_b32 v26, 4, v26
    v_lshl_add_u32 v26, v3, 6, v26
    v_lshl_add_u32 v26, v19, 3, v26
    v_add_u32 v22, s42, v26
    v_xor_b32 v23, 16, v22
    v_xor_b32 v24, 32, v22
    v_xor_b32 v25, 48, v22
    v_lshrrev_b32 v3, 3, v2
    v_xor_b32 v3, v3, v2
    v_and_b32 v3, 3, v3
    v_lshrrev_b32 v19, 2, v2
    v_lshlrev_b32 v19, 10, v19
    v_lshl_add_u32 v27, v3, 4, v19
    s_lshl_b32 s7, s7, 15
    s_lshl_b32 s11, s10, 7
    s_add_u32 s7, s7, s11
    s_lshl_b32 s11, s26, 6
    s_add_u32 s7, s7, s11
    s_waitcnt vmcnt(28)
    ds_read_b64_tr_b16 v[232:233], v248 offset:25600
    ds_read_b64_tr_b16 v[234:235], v248 offset:26624
    ds_read_b64_tr_b16 v[236:237], v249 offset:25600
    ds_read_b64_tr_b16 v[238:239], v249 offset:26624
    s_waitcnt lgkmcnt(0)
    s_waitcnt vmcnt(26)
    ds_read_b64_tr_b16 v[240:241], v250 offset:0
    ds_read_b64_tr_b16 v[242:243], v250 offset:1024
    ds_read_b64_tr_b16 v[244:245], v251 offset:0
    ds_read_b64_tr_b16 v[246:247], v251 offset:1024
    s_waitcnt vmcnt(9)
    v_mfma_f32_32x32x16_bf16 v[32:47], v[232:235], v[192:195], 0
    v_mfma_f32_32x32x16_bf16 v[48:63], v[236:239], v[192:195], 0
    s_add_u32 s12, s12, 2048
    s_cmp_eq_u32 s12, s20
    s_cmov_b32 s12, s29
    buffer_load_dwordx4 v[192:195], v252, s[60:63], s12 offen sc1
    s_waitcnt vmcnt(9)
    v_mfma_f32_32x32x16_bf16 v[64:79], v[232:235], v[196:199], 0
    v_mfma_f32_32x32x16_bf16 v[80:95], v[236:239], v[196:199], 0
    buffer_load_dwordx4 v[196:199], v253, s[60:63], s12 offen sc1
    s_waitcnt lgkmcnt(0)
    s_waitcnt vmcnt(26)
    ds_read_b64_tr_b16 v[232:233], v250 offset:2048
    ds_read_b64_tr_b16 v[234:235], v250 offset:3072
    ds_read_b64_tr_b16 v[236:237], v251 offset:2048
    ds_read_b64_tr_b16 v[238:239], v251 offset:3072
    s_waitcnt vmcnt(9)
    v_mfma_f32_32x32x16_bf16 v[32:47], v[240:243], v[200:203], v[32:47]
    v_mfma_f32_32x32x16_bf16 v[48:63], v[244:247], v[200:203], v[48:63]
    s_add_u32 s12, s12, 2048
    s_cmp_eq_u32 s12, s20
    s_cmov_b32 s12, s29
    buffer_load_dwordx4 v[200:203], v252, s[60:63], s12 offen sc1
    s_waitcnt vmcnt(9)
    v_mfma_f32_32x32x16_bf16 v[64:79], v[240:243], v[204:207], v[64:79]
    v_mfma_f32_32x32x16_bf16 v[80:95], v[244:247], v[204:207], v[80:95]
    buffer_load_dwordx4 v[204:207], v253, s[60:63], s12 offen sc1
    s_waitcnt lgkmcnt(0)
    s_waitcnt vmcnt(26)
    ds_read_b64_tr_b16 v[240:241], v248 offset:0
    ds_read_b64_tr_b16 v[242:243], v248 offset:1024
    ds_read_b64_tr_b16 v[244:245], v249 offset:0
    ds_read_b64_tr_b16 v[246:247], v249 offset:1024
    s_waitcnt vmcnt(9)
    v_mfma_f32_32x32x16_bf16 v[32:47], v[232:235], v[208:211], v[32:47]
    v_mfma_f32_32x32x16_bf16 v[48:63], v[236:239], v[208:211], v[48:63]
    s_add_u32 s12, s12, 2048
    s_cmp_eq_u32 s12, s20
    s_cmov_b32 s12, s29
    buffer_load_dwordx4 v[208:211], v252, s[60:63], s12 offen sc1
    s_waitcnt vmcnt(9)
    v_mfma_f32_32x32x16_bf16 v[64:79], v[232:235], v[212:215], v[64:79]
    v_mfma_f32_32x32x16_bf16 v[80:95], v[236:239], v[212:215], v[80:95]
    buffer_load_dwordx4 v[212:215], v253, s[60:63], s12 offen sc1
    s_waitcnt lgkmcnt(0)
    s_waitcnt vmcnt(26)
    ds_read_b64_tr_b16 v[232:233], v250 offset:4096
    ds_read_b64_tr_b16 v[234:235], v250 offset:5120
    ds_read_b64_tr_b16 v[236:237], v251 offset:4096
    ds_read_b64_tr_b16 v[238:239], v251 offset:5120
    s_waitcnt vmcnt(9)
    v_mfma_f32_32x32x16_bf16 v[32:47], v[240:243], v[216:219], v[32:47]
    v_mfma_f32_32x32x16_bf16 v[48:63], v[244:247], v[216:219], v[48:63]
    s_add_u32 s12, s12, 2048
    s_cmp_eq_u32 s12, s20
    s_cmov_b32 s12, s29
    buffer_load_dwordx4 v[216:219], v252, s[60:63], s12 offen sc1
    s_waitcnt vmcnt(9)
    v_mfma_f32_32x32x16_bf16 v[64:79], v[240:243], v[220:223], v[64:79]
    v_mfma_f32_32x32x16_bf16 v[80:95], v[244:247], v[220:223], v[80:95]
    buffer_load_dwordx4 v[220:223], v253, s[60:63], s12 offen sc1
    s_waitcnt lgkmcnt(0)
    s_waitcnt vmcnt(26)
    ds_read_b64_tr_b16 v[240:241], v250 offset:6144
    ds_read_b64_tr_b16 v[242:243], v250 offset:7168
    ds_read_b64_tr_b16 v[244:245], v251 offset:6144
    ds_read_b64_tr_b16 v[246:247], v251 offset:7168
    s_waitcnt vmcnt(9)
    v_mfma_f32_32x32x16_bf16 v[32:47], v[232:235], v[224:227], v[32:47]
    v_mfma_f32_32x32x16_bf16 v[48:63], v[236:239], v[224:227], v[48:63]
    s_add_u32 s12, s12, 2048
    s_cmp_eq_u32 s12, s20
    s_cmov_b32 s12, s29
    buffer_load_dwordx4 v[224:227], v252, s[60:63], s12 offen sc1
    s_waitcnt vmcnt(9)
    v_mfma_f32_32x32x16_bf16 v[64:79], v[232:235], v[228:231], v[64:79]
    v_mfma_f32_32x32x16_bf16 v[80:95], v[236:239], v[228:231], v[80:95]
    buffer_load_dwordx4 v[228:231], v253, s[60:63], s12 offen sc1
    s_waitcnt lgkmcnt(0)
    s_waitcnt vmcnt(26)
    ds_read_b64_tr_b16 v[232:233], v248 offset:12288
    ds_read_b64_tr_b16 v[234:235], v248 offset:13312
    ds_read_b64_tr_b16 v[236:237], v249 offset:12288
    ds_read_b64_tr_b16 v[238:239], v249 offset:13312
    s_waitcnt vmcnt(9)
    v_mfma_f32_32x32x16_bf16 v[32:47], v[240:243], v[192:195], v[32:47]
    v_mfma_f32_32x32x16_bf16 v[48:63], v[244:247], v[192:195], v[48:63]
    s_mov_b32 s12, s19
    buffer_load_dwordx4 v[192:195], v252, s[60:63], s12 offen sc1
    s_waitcnt vmcnt(9)
    v_mfma_f32_32x32x16_bf16 v[64:79], v[240:243], v[196:199], v[64:79]
    v_mfma_f32_32x32x16_bf16 v[80:95], v[244:247], v[196:199], v[80:95]
    s_add_u32 s12, s12, 2048
    s_cmp_eq_u32 s12, s20
    s_cmov_b32 s12, s29
    buffer_load_dwordx4 v[196:199], v252, s[60:63], s12 offen sc1
    s_waitcnt lgkmcnt(0)
    s_waitcnt vmcnt(26)
    ds_read_b64_tr_b16 v[240:241], v248 offset:14336
    ds_read_b64_tr_b16 v[242:243], v248 offset:2048
    ds_read_b64_tr_b16 v[244:245], v249 offset:14336
    ds_read_b64_tr_b16 v[246:247], v249 offset:2048
    s_waitcnt vmcnt(9)
    v_mfma_f32_32x32x16_bf16 v[32:47], v[232:235], v[200:203], v[32:47]
    v_mfma_f32_32x32x16_bf16 v[48:63], v[236:239], v[200:203], v[48:63]
    s_add_u32 s12, s12, 2048
    s_cmp_eq_u32 s12, s20
    s_cmov_b32 s12, s29
    buffer_load_dwordx4 v[200:203], v252, s[60:63], s12 offen sc1
    s_waitcnt vmcnt(9)
    v_mfma_f32_32x32x16_bf16 v[64:79], v[232:235], v[204:207], v[64:79]
    v_mfma_f32_32x32x16_bf16 v[80:95], v[236:239], v[204:207], v[80:95]
    s_add_u32 s12, s12, 2048
    s_cmp_eq_u32 s12, s20
    s_cmov_b32 s12, s29
    buffer_load_dwordx4 v[204:207], v252, s[60:63], s12 offen sc1
    s_waitcnt lgkmcnt(0)
    s_waitcnt vmcnt(26)
    ds_read_b64_tr_b16 v[232:233], v248 offset:36864
    ds_read_b64_tr_b16 v[234:235], v248 offset:37888
    ds_read_b64_tr_b16 v[236:237], v249 offset:36864
    ds_read_b64_tr_b16 v[238:239], v249 offset:37888
    s_waitcnt vmcnt(9)
    v_mfma_f32_32x32x16_bf16 v[32:47], v[240:243], v[208:211], v[32:47]
    v_mfma_f32_32x32x16_bf16 v[48:63], v[244:247], v[208:211], v[48:63]
    s_add_u32 s12, s12, 2048
    s_cmp_eq_u32 s12, s20
    s_cmov_b32 s12, s29
    buffer_load_dwordx4 v[208:211], v252, s[60:63], s12 offen sc1
    s_waitcnt vmcnt(9)
    v_mfma_f32_32x32x16_bf16 v[64:79], v[240:243], v[212:215], v[64:79]
    v_mfma_f32_32x32x16_bf16 v[80:95], v[244:247], v[212:215], v[80:95]
    s_add_u32 s12, s12, 2048
    s_cmp_eq_u32 s12, s20
    s_cmov_b32 s12, s29
    buffer_load_dwordx4 v[212:215], v252, s[60:63], s12 offen sc1
    s_waitcnt lgkmcnt(0)
    s_waitcnt vmcnt(26)
    ds_read_b64_tr_b16 v[240:241], v248 offset:38912
    ds_read_b64_tr_b16 v[242:243], v248 offset:24576
    ds_read_b64_tr_b16 v[244:245], v249 offset:38912
    ds_read_b64_tr_b16 v[246:247], v249 offset:24576
    s_waitcnt vmcnt(9)
    v_mfma_f32_32x32x16_bf16 v[32:47], v[232:235], v[216:219], v[32:47]
    v_mfma_f32_32x32x16_bf16 v[48:63], v[236:239], v[216:219], v[48:63]
    s_add_u32 s12, s12, 2048
    s_cmp_eq_u32 s12, s20
    s_cmov_b32 s12, s29
    buffer_load_dwordx4 v[216:219], v252, s[60:63], s12 offen sc1
    s_waitcnt vmcnt(9)
    v_mfma_f32_32x32x16_bf16 v[64:79], v[232:235], v[220:223], v[64:79]
    v_mfma_f32_32x32x16_bf16 v[80:95], v[236:239], v[220:223], v[80:95]
    s_add_u32 s12, s12, 2048
    s_cmp_eq_u32 s12, s20
    s_cmov_b32 s12, s29
    buffer_load_dwordx4 v[220:223], v252, s[60:63], s12 offen sc1
    s_waitcnt lgkmcnt(0)
    s_waitcnt vmcnt(9)
    v_mfma_f32_32x32x16_bf16 v[32:47], v[240:243], v[224:227], v[32:47]
    v_mfma_f32_32x32x16_bf16 v[48:63], v[244:247], v[224:227], v[48:63]
    s_add_u32 s12, s12, 2048
    s_cmp_eq_u32 s12, s20
    s_cmov_b32 s12, s29
    buffer_load_dwordx4 v[224:227], v252, s[60:63], s12 offen sc1
    s_waitcnt vmcnt(9)
    v_mfma_f32_32x32x16_bf16 v[64:79], v[240:243], v[228:231], v[64:79]
    v_mfma_f32_32x32x16_bf16 v[80:95], v[244:247], v[228:231], v[80:95]
    s_add_u32 s12, s12, 2048
    s_cmp_eq_u32 s12, s20
    s_cmov_b32 s12, s29
    buffer_load_dwordx4 v[228:231], v252, s[60:63], s12 offen sc1
    s_waitcnt vmcnt(9)
    v_mfma_f32_32x32x16_bf16 v[32:47], v[96:99], v[192:195], v[32:47]
    v_mfma_f32_32x32x16_bf16 v[48:63], v[100:103], v[192:195], v[48:63]
    s_add_u32 s12, s12, 2048
    s_cmp_eq_u32 s12, s20
    s_cmov_b32 s12, s29
    buffer_load_dwordx4 v[192:195], v252, s[60:63], s12 offen sc1
    s_waitcnt vmcnt(9)
    v_mfma_f32_32x32x16_bf16 v[32:47], v[104:107], v[196:199], v[32:47]
    v_mfma_f32_32x32x16_bf16 v[48:63], v[108:111], v[196:199], v[48:63]
    s_add_u32 s12, s12, 2048
    s_cmp_eq_u32 s12, s20
    s_cmov_b32 s12, s29
    buffer_load_dwordx4 v[196:199], v252, s[60:63], s12 offen sc1
    s_waitcnt vmcnt(9)
    v_mfma_f32_32x32x16_bf16 v[32:47], v[112:115], v[200:203], v[32:47]
    v_mfma_f32_32x32x16_bf16 v[48:63], v[116:119], v[200:203], v[48:63]
    s_mov_b32 s12, s19
    buffer_load_dwordx4 v[200:203], v253, s[60:63], s12 offen sc1
    s_waitcnt vmcnt(9)
    v_mfma_f32_32x32x16_bf16 v[32:47], v[120:123], v[204:207], v[32:47]
    v_mfma_f32_32x32x16_bf16 v[48:63], v[124:127], v[204:207], v[48:63]
    s_add_u32 s12, s12, 2048
    s_cmp_eq_u32 s12, s20
    s_cmov_b32 s12, s29
    buffer_load_dwordx4 v[204:207], v253, s[60:63], s12 offen sc1
    s_waitcnt vmcnt(9)
    v_mfma_f32_32x32x16_bf16 v[32:47], v[128:131], v[208:211], v[32:47]
    v_mfma_f32_32x32x16_bf16 v[48:63], v[132:135], v[208:211], v[48:63]
    s_add_u32 s12, s12, 2048
    s_cmp_eq_u32 s12, s20
    s_cmov_b32 s12, s29
    buffer_load_dwordx4 v[208:211], v253, s[60:63], s12 offen sc1
    buffer_load_dword v15, v30, s[56:59], s23 offen sc1
    s_waitcnt vmcnt(10)
    v_mfma_f32_32x32x16_bf16 v[32:47], v[136:139], v[212:215], v[32:47]
    v_mfma_f32_32x32x16_bf16 v[48:63], v[140:143], v[212:215], v[48:63]
    s_add_u32 s12, s12, 2048
    s_cmp_eq_u32 s12, s20
    s_cmov_b32 s12, s29
    buffer_load_dwordx4 v[212:215], v253, s[60:63], s12 offen sc1
    s_waitcnt vmcnt(10)
    v_mfma_f32_32x32x16_bf16 v[32:47], v[144:147], v[216:219], v[32:47]
    v_mfma_f32_32x32x16_bf16 v[48:63], v[148:151], v[216:219], v[48:63]
    s_add_u32 s12, s12, 2048
    s_cmp_eq_u32 s12, s20
    s_cmov_b32 s12, s29
    buffer_load_dwordx4 v[216:219], v253, s[60:63], s12 offen sc1
    s_waitcnt vmcnt(10)
    v_mfma_f32_32x32x16_bf16 v[32:47], v[152:155], v[220:223], v[32:47]
    v_mfma_f32_32x32x16_bf16 v[48:63], v[156:159], v[220:223], v[48:63]
    s_add_u32 s12, s12, 2048
    s_cmp_eq_u32 s12, s20
    s_cmov_b32 s12, s29
    buffer_load_dwordx4 v[220:223], v253, s[60:63], s12 offen sc1
    s_waitcnt vmcnt(10)
    v_mfma_f32_32x32x16_bf16 v[32:47], v[160:163], v[224:227], v[32:47]
    v_mfma_f32_32x32x16_bf16 v[48:63], v[164:167], v[224:227], v[48:63]
    s_add_u32 s12, s12, 2048
    s_cmp_eq_u32 s12, s20
    s_cmov_b32 s12, s29
    buffer_load_dwordx4 v[224:227], v253, s[60:63], s12 offen sc1
    s_waitcnt vmcnt(10)
    v_mfma_f32_32x32x16_bf16 v[32:47], v[168:171], v[228:231], v[32:47]
    v_mfma_f32_32x32x16_bf16 v[48:63], v[172:175], v[228:231], v[48:63]
    s_add_u32 s12, s12, 2048
    s_cmp_eq_u32 s12, s20
    s_cmov_b32 s12, s29
    buffer_load_dwordx4 v[228:231], v253, s[60:63], s12 offen sc1
    s_waitcnt vmcnt(10)
    v_mfma_f32_32x32x16_bf16 v[32:47], v[176:179], v[192:195], v[32:47]
    v_mfma_f32_32x32x16_bf16 v[48:63], v[180:183], v[192:195], v[48:63]
    s_add_u32 s12, s12, 2048
    s_cmp_eq_u32 s12, s20
    s_cmov_b32 s12, s29
    buffer_load_dwordx4 v[192:195], v253, s[60:63], s12 offen sc1
    s_waitcnt vmcnt(10)
    v_mfma_f32_32x32x16_bf16 v[32:47], v[184:187], v[196:199], v[32:47]
    v_mfma_f32_32x32x16_bf16 v[48:63], v[188:191], v[196:199], v[48:63]
    s_add_u32 s12, s12, 2048
    s_cmp_eq_u32 s12, s20
    s_cmov_b32 s12, s29
    buffer_load_dwordx4 v[196:199], v253, s[60:63], s12 offen sc1
    s_waitcnt vmcnt(10)
    v_mfma_f32_32x32x16_bf16 v[64:79], v[96:99], v[200:203], v[64:79]
    v_mfma_f32_32x32x16_bf16 v[80:95], v[100:103], v[200:203], v[80:95]
    s_add_u32 s12, s12, 2048
    s_cmp_eq_u32 s12, s20
    s_cmov_b32 s12, s29
    buffer_load_dwordx4 v[200:203], v253, s[60:63], s12 offen sc1
    s_waitcnt vmcnt(10)
    v_mfma_f32_32x32x16_bf16 v[64:79], v[104:107], v[204:207], v[64:79]
    v_mfma_f32_32x32x16_bf16 v[80:95], v[108:111], v[204:207], v[80:95]
    s_add_u32 s12, s12, 2048
    s_cmp_eq_u32 s12, s20
    s_cmov_b32 s12, s29
    buffer_load_dwordx4 v[204:207], v253, s[60:63], s12 offen sc1
    s_waitcnt vmcnt(10)
    v_mfma_f32_32x32x16_bf16 v[64:79], v[112:115], v[208:211], v[64:79]
    v_mfma_f32_32x32x16_bf16 v[80:95], v[116:119], v[208:211], v[80:95]
    s_load_dwordx16 s[68:83], s[40:41], s8 glc
    s_waitcnt vmcnt(8)
    v_mfma_f32_32x32x16_bf16 v[64:79], v[120:123], v[212:215], v[64:79]
    v_mfma_f32_32x32x16_bf16 v[80:95], v[124:127], v[212:215], v[80:95]
    ds_write_b128 v29, v[32:35] offset:0
    s_waitcnt vmcnt(7)
    v_mfma_f32_32x32x16_bf16 v[64:79], v[128:131], v[216:219], v[64:79]
    v_mfma_f32_32x32x16_bf16 v[80:95], v[132:135], v[216:219], v[80:95]
    ds_write_b128 v29, v[36:39] offset:1024
    s_waitcnt vmcnt(6)
    v_mfma_f32_32x32x16_bf16 v[64:79], v[136:139], v[220:223], v[64:79]
    v_mfma_f32_32x32x16_bf16 v[80:95], v[140:143], v[220:223], v[80:95]
    ds_write_b128 v29, v[40:43] offset:2048
    s_waitcnt vmcnt(5)
    v_mfma_f32_32x32x16_bf16 v[64:79], v[144:147], v[224:227], v[64:79]
    v_mfma_f32_32x32x16_bf16 v[80:95], v[148:151], v[224:227], v[80:95]
    ds_write_b128 v29, v[44:47] offset:3072
    s_waitcnt vmcnt(4)
    v_mfma_f32_32x32x16_bf16 v[64:79], v[152:155], v[228:231], v[64:79]
    v_mfma_f32_32x32x16_bf16 v[80:95], v[156:159], v[228:231], v[80:95]
    s_waitcnt lgkmcnt(0)
    s_mov_b64 vcc, s[68:69]
    s_or_b64 vcc, vcc, s[70:71]
    s_and_b64 s[68:69], s[68:69], s[70:71]
    s_or_b64 vcc, vcc, s[72:73]
    s_and_b64 s[68:69], s[68:69], s[72:73]
    s_or_b64 vcc, vcc, s[74:75]
    s_and_b64 s[68:69], s[68:69], s[74:75]
    s_or_b64 vcc, vcc, s[76:77]
    s_and_b64 s[68:69], s[68:69], s[76:77]
    s_or_b64 vcc, vcc, s[78:79]
    s_and_b64 s[68:69], s[68:69], s[78:79]
    s_or_b64 vcc, vcc, s[80:81]
    s_and_b64 s[68:69], s[68:69], s[80:81]
    s_or_b64 vcc, vcc, s[82:83]
    s_and_b64 s[68:69], s[68:69], s[82:83]
    s_or_b32 vcc_lo, vcc_lo, vcc_hi
    s_and_b32 s68, s68, s69
    s_xor_b32 vcc_lo, vcc_lo, s13
    s_xor_b32 s68, s68, s13
    s_or_b32 s68, s68, vcc_lo
    s_cselect_b32 s14, 1, 0
    s_cselect_b32 s0, 1073741824, s6
    s_add_u32 s11, s0, 0
    buffer_load_dword v232, v14, s[56:59], s11 offen sc1
    s_add_u32 s11, s0, 8192
    buffer_load_dword v234, v14, s[56:59], s11 offen sc1
    ds_write_b128 v29, v[48:51] offset:4096
    s_waitcnt vmcnt(5)
    v_mfma_f32_32x32x16_bf16 v[64:79], v[160:163], v[192:195], v[64:79]
    v_mfma_f32_32x32x16_bf16 v[80:95], v[164:167], v[192:195], v[80:95]
    s_add_u32 s11, s0, 32768
    buffer_load_dword v236, v14, s[56:59], s11 offen sc1
    s_add_u32 s11, s0, 40960
    buffer_load_dword v238, v14, s[56:59], s11 offen sc1
    ds_write_b128 v29, v[52:55] offset:5120
    s_waitcnt vmcnt(6)
    v_mfma_f32_32x32x16_bf16 v[64:79], v[168:171], v[196:199], v[64:79]
    v_mfma_f32_32x32x16_bf16 v[80:95], v[172:175], v[196:199], v[80:95]
    s_add_u32 s11, s0, 65536
    buffer_load_dword v240, v14, s[56:59], s11 offen sc1
    s_add_u32 s11, s0, 73728
    buffer_load_dword v242, v14, s[56:59], s11 offen sc1
    ds_write_b128 v29, v[56:59] offset:6144
    s_waitcnt vmcnt(7)
    v_mfma_f32_32x32x16_bf16 v[64:79], v[176:179], v[200:203], v[64:79]
    v_mfma_f32_32x32x16_bf16 v[80:95], v[180:183], v[200:203], v[80:95]
    s_add_u32 s11, s0, 98304
    buffer_load_dword v244, v14, s[56:59], s11 offen sc1
    s_add_u32 s11, s0, 106496
    buffer_load_dword v246, v14, s[56:59], s11 offen sc1
    ds_write_b128 v29, v[60:63] offset:7168
    s_waitcnt vmcnt(8)
    v_mfma_f32_32x32x16_bf16 v[64:79], v[184:187], v[204:207], v[64:79]
    v_mfma_f32_32x32x16_bf16 v[80:95], v[188:191], v[204:207], v[80:95]
    s_nop 10
    ds_write_b128 v28, v[64:67] offset:0
    ds_write_b128 v28, v[68:71] offset:1024
    ds_write_b128 v28, v[72:75] offset:2048
    ds_write_b128 v28, v[76:79] offset:12288
    v_and_b32 v16, 0xffff0000, v15
    v_rcp_f32 v16, v16
    s_waitcnt lgkmcnt(0)
    s_barrier
    ds_read_b128 v[96:99], v17 offset:0
    ds_read_b128 v[112:115], v20 offset:4096
    ds_read_b128 v[128:131], v21 offset:32768
    ds_read_b128 v[100:103], v17 offset:1024
    ds_read_b128 v[116:119], v20 offset:5120
    ds_read_b128 v[132:135], v21 offset:33792
    ds_read_b128 v[104:107], v17 offset:2048
    ds_read_b128 v[120:123], v20 offset:6144
    ds_read_b128 v[136:139], v21 offset:34816
    ds_read_b128 v[108:111], v17 offset:3072
    ds_read_b128 v[124:127], v20 offset:7168
    ds_read_b128 v[140:143], v21 offset:45056
    s_waitcnt lgkmcnt(9)
    v_add_f32 v96, v96, v112
    v_add_f32 v97, v97, v113
    v_add_f32 v98, v98, v114
    v_add_f32 v99, v99, v115
    v_add_f32 v80, v80, v128
    v_add_f32 v81, v81, v129
    v_add_f32 v82, v82, v130
    v_add_f32 v83, v83, v131
    v_add_f32 v80, v80, v96
    v_add_f32 v81, v81, v97
    v_add_f32 v82, v82, v98
    v_add_f32 v83, v83, v99
    s_waitcnt lgkmcnt(6)
    v_add_f32 v100, v100, v116
    v_add_f32 v101, v101, v117
    v_add_f32 v102, v102, v118
    v_add_f32 v103, v103, v119
    v_add_f32 v84, v84, v132
    v_add_f32 v85, v85, v133
    v_add_f32 v86, v86, v134
    v_add_f32 v87, v87, v135
    v_add_f32 v84, v84, v100
    v_add_f32 v85, v85, v101
    v_add_f32 v86, v86, v102
    v_add_f32 v87, v87, v103
    s_waitcnt lgkmcnt(3)
    v_add_f32 v104, v104, v120
    v_add_f32 v105, v105, v121
    v_add_f32 v106, v106, v122
    v_add_f32 v107, v107, v123
    v_add_f32 v88, v88, v136
    v_add_f32 v89, v89, v137
    v_add_f32 v90, v90, v138
    v_add_f32 v91, v91, v139
    v_add_f32 v88, v88, v104
    v_add_f32 v89, v89, v105
    v_add_f32 v90, v90, v106
    v_add_f32 v91, v91, v107
    s_waitcnt lgkmcnt(0)
    v_add_f32 v108, v108, v124
    v_add_f32 v109, v109, v125
    v_add_f32 v110, v110, v126
    v_add_f32 v111, v111, v127
    v_add_f32 v92, v92, v140
    v_add_f32 v93, v93, v141
    v_add_f32 v94, v94, v142
    v_add_f32 v95, v95, v143
    v_add_f32 v92, v92, v108
    v_add_f32 v93, v93, v109
    v_add_f32 v94, v94, v110
    v_add_f32 v95, v95, v111
    s_cmp_lg_u32 s14, 0
    s_cbranch_scc1 L_slow3
L_ret3:
    s_waitcnt vmcnt(0)
    v_lshlrev_b32 v144, 16, v232
    v_and_b32 v145, 0xffff0000, v232
    v_lshlrev_b32 v146, 16, v234
    v_and_b32 v147, 0xffff0000, v234
    v_fmac_f32 v144, v80, v16
    v_fmac_f32 v145, v81, v16
    v_fmac_f32 v146, v82, v16
    v_fmac_f32 v147, v83, v16
    v_cvt_pk_bf16_f32 v32, v144, v145
    v_cvt_pk_bf16_f32 v33, v146, v147
    ds_write_b64 v22, v[32:33] offset:24576
    v_lshlrev_b32 v148, 16, v236
    v_and_b32 v149, 0xffff0000, v236
    v_lshlrev_b32 v150, 16, v238
    v_and_b32 v151, 0xffff0000, v238
    v_fmac_f32 v148, v84, v16
    v_fmac_f32 v149, v85, v16
    v_fmac_f32 v150, v86, v16
    v_fmac_f32 v151, v87, v16
    v_cvt_pk_bf16_f32 v34, v148, v149
    v_cvt_pk_bf16_f32 v35, v150, v151
    ds_write_b64 v23, v[34:35] offset:24576
    v_lshlrev_b32 v152, 16, v240
    v_and_b32 v153, 0xffff0000, v240
    v_lshlrev_b32 v154, 16, v242
    v_and_b32 v155, 0xffff0000, v242
    v_fmac_f32 v152, v88, v16
    v_fmac_f32 v153, v89, v16
    v_fmac_f32 v154, v90, v16
    v_fmac_f32 v155, v91, v16
    v_cvt_pk_bf16_f32 v36, v152, v153
    v_cvt_pk_bf16_f32 v37, v154, v155
    ds_write_b64 v24, v[36:37] offset:24576
    v_lshlrev_b32 v156, 16, v244
    v_and_b32 v157, 0xffff0000, v244
    v_lshlrev_b32 v158, 16, v246
    v_and_b32 v159, 0xffff0000, v246
    v_fmac_f32 v156, v92, v16
    v_fmac_f32 v157, v93, v16
    v_fmac_f32 v158, v94, v16
    v_fmac_f32 v159, v95, v16
    v_cvt_pk_bf16_f32 v38, v156, v157
    v_cvt_pk_bf16_f32 v39, v158, v159
    ds_write_b64 v25, v[38:39] offset:24576
    s_waitcnt lgkmcnt(0)
    ds_read_b128 v[40:43], v28 offset:24576
    ds_read_b128 v[44:47], v28 offset:25600
    s_waitcnt lgkmcnt(1)
    s_add_u32 s11, s7, 0
    buffer_store_dwordx4 v[40:43], v27, s[64:67], s11 offen sc1
    s_waitcnt lgkmcnt(0)
    s_add_u32 s11, s7, 16384
    buffer_store_dwordx4 v[44:47], v27, s[64:67], s11 offen sc1
    s_endpgm
L_ssm:
    s_setprio 3
    s_lshl_b32 s6, s4, 2
    s_lshr_b32 s11, s5, 3
    s_add_u32 s6, s6, s11
    s_and_b32 s7, s5, 7
    s_lshl_b32 s8, s4, 5
    s_add_u32 s8, s8, s5
    s_lshr_b32 s9, s3, 1
    s_and_b32 s10, s3, 1
    v_lshlrev_b32 v4, 4, v2
    v_lshrrev_b32 v3, 3, v2
    v_lshlrev_b32 v3, 10, v3
    v_lshrrev_b32 v9, 5, v2
    s_lshl_b32 s11, s10, 2
    v_xor_b32 v9, s11, v9
    v_xor_b32 v9, v9, v2
    v_and_b32 v9, 7, v9
    v_lshl_add_u32 v5, v9, 4, v3
    v_xor_b32 v6, 32, v5
    v_add_u32 v6, 7168, v6
    s_lshl_b32 s11, s8, 9
    v_lshl_add_u32 v7, v0, 1, s11
    s_lshl_b32 s11, s8, 2
    s_lshl_b32 s12, s9, 1
    s_add_u32 s11, s11, s12
    v_mov_b32 v8, s11
    s_lshl_b32 s13, s6, 16
    s_lshl_b32 s11, s3, 14
    s_add_u32 s14, s13, s11
    s_lshl_b32 s11, s7, 7
    s_add_u32 s14, s14, s11
    s_lshl_b32 s11, s7, 13
    s_add_u32 s13, s13, s11
    s_lshl_b32 s11, s3, 11
    s_add_u32 s13, s13, s11
    s_add_u32 s15, s11, 73728
    v_mov_b32 v3, 0
    s_waitcnt lgkmcnt(0)
    s_mov_b32 s44, s16
    s_mov_b32 s45, s17
    s_mov_b32 s46, 2097152
    s_mov_b32 s47, 0x00020000
    s_mov_b32 s56, s40
    s_mov_b32 s57, s41
    s_mov_b32 s58, 15728640
    s_mov_b32 s59, 0x00020000
    s_mov_b32 m0, s15
    s_nop 0
    buffer_load_dwordx4 v5, s[44:47], s14 offen offset:0 lds
    buffer_load_dwordx4 v6, s[44:47], s14 offen offset:1024 lds
    buffer_load_dwordx4 v[12:15], v4, s[44:47], s13 offen
    buffer_load_dwordx4 v[16:19], v4, s[44:47], s13 offen offset:1024
    buffer_load_dword v26, v3, s[56:59], 0 offen sc1
    global_load_ushort v20, v7, s[18:19]
    global_load_ushort v21, v7, s[20:21]
    global_load_ushort v22, v7, s[22:23]
    global_load_ushort v23, v7, s[24:25]
    global_load_ushort v24, v8, s[26:27]
    global_load_ushort v25, v8, s[28:29]
    s_setprio 3
    v_lshlrev_b32 v10, 4, v0
    s_lshl_b32 s11, s3, 11
    s_add_u32 s11, s11, 65536
    v_add_u32 v51, s11, v4
    v_xor_b32 v52, 2048, v51
    v_and_b32 v3, 15, v2
    v_lshrrev_b32 v9, 4, v2
    v_add_u32 v47, 51200, v10
    v_lshlrev_b32 v11, 1, v10
    v_add_u32 v49, 55552, v11
    s_lshl_b32 s11, s3, 10
    s_add_u32 s12, s11, 51200
    v_lshl_add_u32 v48, v9, 6, s12
    s_lshl_b32 s11, s11, 1
    s_add_u32 s12, s11, 55552
    v_lshl_add_u32 v50, v9, 7, s12
    v_lshrrev_b32 v11, 2, v3
    v_max_u32 v11, 1, v11
    v_lshl_add_u32 v53, v11, 3, v50
    v_add_u32 v53, -8, v53
    v_cvt_f32_u32 v27, v3
    v_mul_f32 v44, 4.0, v27
    v_mul_f32 v27, 0x42800000, v27
    v_add_f32 v45, 2.0, v27
    v_add_f32 v28, 0xc3ff8000, v27
    v_add_f32 v27, 0xc43f4000, v27
    v_cmp_gt_u32 vcc, 12, v3
    s_nop 1
    v_cndmask_b32 v27, v27, v28, vcc
    v_cmp_gt_u32 vcc, 8, v3
    s_nop 1
    v_cndmask_b32 v45, v27, v45, vcc
    s_mul_i32 s15, s9, 2816
    s_add_u32 s15, s15, 45068
    s_mov_b32 s52, 822165506
    s_mov_b32 s53, 1073954817
    s_mov_b32 s54, 822231044
    s_mov_b32 s55, 566305153
    v_lshlrev_b32 v10, 4, v9
    v_lshrrev_b64 v[28:29], v10, s[52:53]
    v_bfe_u32 v29, v28, 12, 3
    v_and_b32 v28, 0x3ff, v28
    v_lshl_add_u32 v28, v28, 2, s15
    v_lshl_add_u32 v32, v3, v29, v28
    v_lshlrev_b32 v29, v29, 16
    v_add_u32 v33, v29, v32
    v_add_u32 v34, v29, v33
    v_add_u32 v35, v29, v34
    v_lshrrev_b64 v[28:29], v10, s[54:55]
    v_bfe_u32 v29, v28, 12, 3
    v_and_b32 v28, 0x3ff, v28
    v_lshl_add_u32 v28, v28, 2, s15
    v_lshl_add_u32 v36, v3, v29, v28
    v_lshlrev_b32 v29, v29, 16
    v_add_u32 v37, v29, v36
    v_add_u32 v38, v29, v37
    v_add_u32 v39, v29, v38
    v_lshlrev_b32 v28, 1, v3
    v_lshl_add_u32 v28, v9, 7, v28
    s_add_u32 s11, s15, 2050
    v_add_u32 v28, s11, v28
    v_and_b32 v29, 1, v3
    v_cmp_eq_u32 vcc, 1, v29
    v_mov_b32 v29, 50688
    s_nop 0
    v_cndmask_b32 v40, v29, v28, vcc
    v_lshlrev_b32 v10, 3, v0
    v_add_u32 v11, -3, v10
    v_cvt_f32_i32 v27, v11
    v_lshlrev_b32 v10, 5, v0
    v_add_u32 v10, 45056, v10
    v_add_f32 v28, 1.0, v27
    v_cmp_gt_u32 vcc, 17, v0
    s_mov_b32 s11, -23028
    v_cvt_pk_bf16_f32 v11, v27, v28
    v_add_f32 v27, 2.0, v27
    v_add_f32 v28, 2.0, v28
    v_mad_u32_u16 v64, v11, 4, s11 op_sel:[0,0,0,0]
    s_sub_u32 s11, s11, 4
    v_cndmask_b32 v64, v64, v10, vcc
    v_mad_u32_u16 v65, v11, 4, s11 op_sel:[1,0,0,0]
    s_sub_u32 s11, s11, 4
    v_cndmask_b32 v65, v65, v10, vcc
    v_cvt_pk_bf16_f32 v11, v27, v28
    v_add_f32 v27, 2.0, v27
    v_add_f32 v28, 2.0, v28
    v_mad_u32_u16 v66, v11, 4, s11 op_sel:[0,0,0,0]
    s_sub_u32 s11, s11, 4
    v_cndmask_b32 v66, v66, v10, vcc
    v_mad_u32_u16 v67, v11, 4, s11 op_sel:[1,0,0,0]
    s_sub_u32 s11, s11, 4
    v_cndmask_b32 v67, v67, v10, vcc
    v_cvt_pk_bf16_f32 v11, v27, v28
    v_add_f32 v27, 2.0, v27
    v_add_f32 v28, 2.0, v28
    v_mad_u32_u16 v68, v11, 4, s11 op_sel:[0,0,0,0]
    s_sub_u32 s11, s11, 4
    v_cndmask_b32 v68, v68, v10, vcc
    v_mad_u32_u16 v69, v11, 4, s11 op_sel:[1,0,0,0]
    s_sub_u32 s11, s11, 4
    v_cndmask_b32 v69, v69, v10, vcc
    v_cvt_pk_bf16_f32 v11, v27, v28
    v_add_f32 v27, 2.0, v27
    v_add_f32 v28, 2.0, v28
    v_mad_u32_u16 v70, v11, 4, s11 op_sel:[0,0,0,0]
    s_sub_u32 s11, s11, 4
    v_cndmask_b32 v70, v70, v10, vcc
    v_mad_u32_u16 v71, v11, 4, s11 op_sel:[1,0,0,0]
    s_sub_u32 s11, s11, 4
    v_cndmask_b32 v71, v71, v10, vcc
    v_cvt_pk_bf16_f32 v11, v27, v28
    v_add_f32 v27, 2.0, v27
    v_add_f32 v28, 2.0, v28
    v_mad_u32_u16 v72, v11, 4, s11 op_sel:[0,0,0,0]
    s_sub_u32 s11, s11, 4
    v_cndmask_b32 v72, v72, v10, vcc
    v_mad_u32_u16 v73, v11, 4, s11 op_sel:[1,0,0,0]
    s_sub_u32 s11, s11, 4
    v_cndmask_b32 v73, v73, v10, vcc
    v_cvt_pk_bf16_f32 v11, v27, v28
    v_mad_u32_u16 v74, v11, 4, s11 op_sel:[0,0,0,0]
    s_sub_u32 s11, s11, 4
    v_cndmask_b32 v74, v74, v10, vcc
    v_lshlrev_b32 v11, 4, v0
    v_sub_u32 v75, 4080, v11
    v_and_b32 v10, 3, v3
    v_mul_u32_u24 v10, 4160, v10
    v_lshrrev_b32 v11, 2, v3
    v_lshlrev_b32 v11, 3, v11
    v_sub_u32 v10, v10, v11
    v_lshl_add_u32 v10, v9, 4, v10
    s_mul_i32 s11, s9, 16640
    s_lshl_b32 s12, s10, 8
    s_sub_u32 s11, s11, s12
    s_add_u32 s11, s11, 280
    v_add_u32 v76, s11, v10
    v_lshlrev_b32 v10, 5, v3
    v_lshl_add_u32 v10, v9, 4, v10
    s_mul_i32 s11, s9, 4608
    s_sub_u32 s11, s11, s12
    s_add_u32 s11, s11, 33280
    v_add_u32 v77, s11, v10
    v_and_b32 v10, 7, v2
    v_lshrrev_b32 v11, 5, v2
    s_lshl_b32 s11, s3, 1
    v_add_u32 v11, s11, v11
    v_xor_b32 v11, v11, v10
    v_lshlrev_b32 v11, 4, v11
    v_lshl_add_u32 v11, v10, 9, v11
    v_bfe_u32 v27, v2, 3, 2
    v_lshl_add_u32 v11, v27, 2, v11
    v_add_u32 v78, 73728, v11
    v_lshrrev_b32 v11, 3, v2
    v_lshlrev_b32 v11, 13, v11
    v_lshl_add_u32 v80, v10, 4, v11
    v_lshlrev_b32 v85, 3, v2
    s_lshl_b32 s11, s3, 10
    s_add_u32 s11, s11, 33760
    v_add_u32 v81, s11, v85
    v_bfe_u32 v10, v3, 1, 2
    v_xor_b32 v10, v10, v9
    v_lshlrev_b32 v10, 4, v10
    v_lshl_add_u32 v10, v3, 6, v10
    s_lshl_b32 s11, s3, 13
    s_add_u32 s11, s11, 42496
    v_add_u32 v82, s11, v10
    v_bfe_u32 v10, v2, 3, 2
    v_lshlrev_b32 v10, 4, v10
    v_xor_b32 v10, v10, v4
    s_lshl_b32 s11, s3, 11
    s_add_u32 s11, s11, 42496
    v_add_u32 v83, s11, v10
    s_waitcnt vmcnt(6)
    s_barrier
    ds_read_b32 v104, v78 offset:0
    ds_read_b32 v105, v78 offset:128
    ds_read_b32 v106, v78 offset:256
    ds_read_b32 v107, v78 offset:384
    ds_read_b32 v108, v78 offset:4096
    ds_read_b32 v109, v78 offset:4224
    ds_read_b32 v110, v78 offset:4352
    ds_read_b32 v111, v78 offset:4480
    v_add_u32 v26, 2654435769, v26
    v_mov_b32 v96, 0
    v_mov_b32 v97, 0
    s_mov_b32 s11, 0x3f803f80
    v_dot2c_f32_bf16 v96, s11, v12
    v_dot2c_f32_bf16 v97, s11, v16
    v_dot2c_f32_bf16 v96, s11, v13
    v_dot2c_f32_bf16 v97, s11, v17
    v_dot2c_f32_bf16 v96, s11, v14
    v_dot2c_f32_bf16 v97, s11, v18
    v_dot2c_f32_bf16 v96, s11, v15
    v_dot2c_f32_bf16 v97, s11, v19
    s_lshl_b32 s11, s7, 2
    s_add_u32 s11, s11, s3
    s_lshl_b32 s48, s11, 7
    s_lshl_b32 s11, s11, 16
    s_lshl_b32 s12, s6, 8
    s_add_u32 s11, s11, s12
    s_add_u32 s11, s11, 1048576
    s_lshl_b32 s12, s6, 2
    s_add_u32 s48, s48, s12
    s_add_u32 s48, s48, 4096
    v_readfirstlane_b32 s49, v26
    s_waitcnt lgkmcnt(0)
    s_setprio 3
    buffer_store_dwordx4 v[104:107], v80, s[56:59], s11 offen offset:0 sc1
    buffer_store_dwordx4 v[108:111], v80, s[56:59], s11 offen offset:128 sc1
    s_setprio 3
    s_waitcnt vmcnt(2)
    v_add_f32_dpp v96, v96, v96 quad_perm:[1,0,3,2] row_mask:0xf bank_mask:0xf
    v_lshlrev_b32 v20, 16, v20
    v_add_f32_dpp v97, v97, v97 quad_perm:[1,0,3,2] row_mask:0xf bank_mask:0xf
    v_lshlrev_b32 v24, 16, v24
    v_lshlrev_b32 v21, 16, v21
    v_add_f32_dpp v96, v96, v96 quad_perm:[2,3,0,1] row_mask:0xf bank_mask:0xf
    v_lshlrev_b32 v22, 16, v22
    v_lshlrev_b32 v23, 16, v23
    v_add_f32_dpp v97, v97, v97 quad_perm:[2,3,0,1] row_mask:0xf bank_mask:0xf
    v_lshlrev_b32 v25, 16, v25
    v_add_f32_dpp v96, v96, v96 row_half_mirror row_mask:0xf bank_mask:0xf
    s_mov_b32 s52, 0x3fb8aa3b
    s_mov_b32 s53, 0x32a57060
    v_add_f32_dpp v97, v97, v97 row_half_mirror row_mask:0xf bank_mask:0xf
    v_mul_f32 v118, s52, v20
    v_mul_f32 v120, s52, v24
    v_add_f32_dpp v96, v96, v96 row_mirror row_mask:0xf bank_mask:0xf
    v_fma_f32 v119, v20, s52, -v118
    v_add_f32_dpp v97, v97, v97 row_mirror row_mask:0xf bank_mask:0xf
    v_fma_f32 v121, v24, s52, -v120
    v_exp_f32 v118, v118
    v_add_f32_dpp v96, v96, v96 row_bcast:15 row_mask:0xa bank_mask:0xf
    v_exp_f32 v120, v120
    v_fmac_f32 v119, s53, v20
    v_add_f32_dpp v97, v97, v97 row_bcast:15 row_mask:0xa bank_mask:0xf
    v_fmac_f32 v121, s53, v24
    v_add_f32_dpp v96, v96, v96 row_bcast:31 row_mask:0xc bank_mask:0xf
    v_mul_f32 v119, 0x3f317218, v119
    v_mul_f32 v121, 0x3f317218, v121
    v_add_f32_dpp v97, v97, v97 row_bcast:31 row_mask:0xc bank_mask:0xf
    v_fmac_f32 v118, v118, v119
    v_fmac_f32 v120, v120, v121
    v_readlane_b32 s12, v96, 63
    v_readlane_b32 s13, v97, 63
    v_mov_b32 v98, 0x3b000000
    v_mov_b32 v96, 0
    v_cvt_pk_bf16_f32 v118, v118, v120
    v_mov_b32 v97, 0
    v_mul_f32 v99, s13, v98
    v_mul_f32 v98, s12, v98
    v_lshlrev_b32 v100, 16, v12
    v_and_b32 v120, 0xffff0000, v118
    v_and_b32 v101, 0xffff0000, v12
    v_sub_f32 v100, v100, v98
    v_sub_f32 v101, v101, v98
    v_fmac_f32 v96, v100, v100
    v_lshlrev_b32 v118, 16, v118
    v_fmac_f32 v96, v101, v101
    v_lshlrev_b32 v102, 16, v16
    v_and_b32 v103, 0xffff0000, v16
    v_sub_f32 v102, v102, v99
    v_mul_f32 v112, v118, v120
    v_sub_f32 v103, v103, v99
    v_fmac_f32 v97, v102, v102
    v_fmac_f32 v97, v103, v103
    v_lshlrev_b32 v100, 16, v13
    v_mul_f32 v113, v21, v120
    v_and_b32 v101, 0xffff0000, v13
    v_sub_f32 v100, v100, v98
    v_sub_f32 v101, v101, v98
    v_fmac_f32 v96, v100, v100
    v_add_f32 v121, v120, v120
    v_fmac_f32 v96, v101, v101
    v_lshlrev_b32 v102, 16, v17
    v_and_b32 v103, 0xffff0000, v17
    v_sub_f32 v102, v102, v99
    v_mul_f32 v112, 0xbfb8aa3b, v112
    v_sub_f32 v103, v103, v99
    v_fmac_f32 v97, v102, v102
    v_fmac_f32 v97, v103, v103
    v_lshlrev_b32 v100, 16, v14
    v_mul_f32 v113, 0.15915494, v113
    v_and_b32 v101, 0xffff0000, v14
    v_sub_f32 v100, v100, v98
    v_sub_f32 v101, v101, v98
    v_fmac_f32 v96, v100, v100
    v_mul_f32 v114, v22, v121
    v_fmac_f32 v96, v101, v101
    v_lshlrev_b32 v102, 16, v18
    v_and_b32 v103, 0xffff0000, v18
    v_sub_f32 v102, v102, v99
    v_mul_f32 v115, v23, v121
    v_sub_f32 v103, v103, v99
    v_fmac_f32 v97, v102, v102
    v_fmac_f32 v97, v103, v103
    v_lshlrev_b32 v100, 16, v15
    v_rndne_f32 v118, v113
    v_and_b32 v101, 0xffff0000, v15
    v_sub_f32 v100, v100, v98
    v_sub_f32 v101, v101, v98
    v_fmac_f32 v96, v100, v100
    v_mov_b32 v116, v114
    v_fmac_f32 v96, v101, v101
    v_lshlrev_b32 v102, 16, v19
    v_and_b32 v103, 0xffff0000, v19
    v_sub_f32 v102, v102, v99
    v_sub_f32 v113, v113, v118
    v_sub_f32 v103, v103, v99
    v_fmac_f32 v97, v102, v102
    v_fmac_f32 v97, v103, v103
    ds_write_b128 v47, v[112:115]
    v_add_f32_dpp v96, v96, v96 quad_perm:[1,0,3,2] row_mask:0xf bank_mask:0xf
    v_add_f32_dpp v97, v97, v97 quad_perm:[1,0,3,2] row_mask:0xf bank_mask:0xf
    v_add_f32_dpp v116, v116, v116 quad_perm:[1,0,3,2] row_mask:0xf bank_mask:0xf
    v_add_f32_dpp v96, v96, v96 quad_perm:[2,3,0,1] row_mask:0xf bank_mask:0xf
    v_add_f32_dpp v97, v97, v97 quad_perm:[2,3,0,1] row_mask:0xf bank_mask:0xf
    v_add_f32_dpp v116, v116, v116 quad_perm:[2,3,0,1] row_mask:0xf bank_mask:0xf
    v_add_f32_dpp v96, v96, v96 row_half_mirror row_mask:0xf bank_mask:0xf
    v_add_f32_dpp v97, v97, v97 row_half_mirror row_mask:0xf bank_mask:0xf
    v_add_f32_dpp v116, v116, v116 row_half_mirror row_mask:0xf bank_mask:0xf
    v_add_f32_dpp v96, v96, v96 row_mirror row_mask:0xf bank_mask:0xf
    v_add_f32_dpp v97, v97, v97 row_mirror row_mask:0xf bank_mask:0xf
    v_add_f32_dpp v116, v116, v116 row_mirror row_mask:0xf bank_mask:0xf
    v_add_f32_dpp v96, v96, v96 row_bcast:15 row_mask:0xa bank_mask:0xf
    v_add_f32_dpp v97, v97, v97 row_bcast:15 row_mask:0xa bank_mask:0xf
    v_add_f32_dpp v116, v116, v116 row_bcast:15 row_mask:0xa bank_mask:0xf
    v_add_f32_dpp v96, v96, v96 row_bcast:31 row_mask:0xc bank_mask:0xf
    v_add_f32_dpp v97, v97, v97 row_bcast:31 row_mask:0xc bank_mask:0xf
    v_add_f32_dpp v116, v116, v116 row_bcast:31 row_mask:0xc bank_mask:0xf
    v_mul_f32 v96, 0x3b000000, v96
    v_mul_f32 v129, 0x40000000, v113
    v_mul_f32 v97, 0x3b000000, v97
    v_mul_f32 v131, 0x4400c000, v113
    v_cvt_pk_bf16_f32 v96, v96, v97
    v_mul_f32 v133, 0x44404000, v113
    v_lshlrev_b32 v100, 16, v96
    v_mul_f32 v135, 0x44800000, v113
    v_and_b32 v101, 0xffff0000, v96
    v_mul_f32 v118, 0x40000000, v112
    v_add_f32 v100, 0x3727c5ac, v100
    v_mul_f32 v119, 0x4400c000, v112
    v_add_f32 v101, 0x3727c5ac, v101
    v_mul_f32 v120, 0x44404000, v112
    v_cvt_pk_bf16_f32 v96, v100, v101
    v_mul_f32 v121, 0x44800000, v112
    v_lshlrev_b32 v100, 16, v96
    v_fract_f32 v129, v129
    v_and_b32 v101, 0xffff0000, v96
    v_fract_f32 v131, v131
    v_sqrt_f32 v100, v100
    v_fract_f32 v133, v133
    v_sqrt_f32 v101, v101
    v_fract_f32 v135, v135
    v_mov_b32 v89, v26
    v_exp_f32 v118, v118
    v_mov_b32 v91, v26
    v_exp_f32 v119, v119
    v_cvt_pk_bf16_f32 v88, v98, v100
    v_exp_f32 v120, v120
    v_cvt_pk_bf16_f32 v90, v99, v101
    v_exp_f32 v121, v121
    s_lshl_b32 s11, s6, 3
    s_add_u32 s11, s11, s7
    s_lshl_b32 s11, s11, 5
    s_lshl_b32 s12, s9, 4
    s_add_u32 s11, s11, s12
    s_lshl_b32 s12, s10, 13
    s_add_u32 s11, s11, s12
    s_add_u32 s11, s11, 16384
    s_lshl_b32 s12, s3, 2
    s_add_u32 s12, s12, 64512
    v_mov_b32 v10, s12
    v_mov_b32 v3, 0
    s_mov_b32 s42, s15
    s_setprio 3
    s_mov_b32 exec_lo, 0
    s_mov_b32 exec_hi, 0x80000000
    buffer_store_dwordx4 v[88:91], v3, s[56:59], s11 offen sc1
    ds_write_b32 v10, v116
    s_mov_b64 exec, -1
    s_setprio 3
    v_cos_f32 v128, v129
    v_cos_f32 v130, v131
    v_cos_f32 v132, v133
    v_cos_f32 v134, v135
    v_sin_f32 v129, v129
    v_sin_f32 v131, v131
    v_sin_f32 v133, v133
    v_sin_f32 v135, v135
    v_mul_f32 v128, v128, v118
    v_mul_f32 v130, v130, v119
    v_mul_f32 v132, v132, v120
    v_mul_f32 v134, v134, v121
    v_mul_f32 v129, v129, v118
    v_mul_f32 v131, v131, v119
    v_mul_f32 v133, v133, v120
    v_mul_f32 v135, v135, v121
    ds_write_b128 v49, v[128:131]
    ds_write_b128 v49, v[132:135] offset:16
    s_waitcnt lgkmcnt(0)
    ds_read_b128 v[160:163], v48 offset:0
    ds_read_b64 v[144:145], v53 offset:0
    ds_read_b64 v[176:177], v50 offset:24
    ds_read_b128 v[164:167], v48 offset:16
    ds_read_b64 v[146:147], v53 offset:32
    ds_read_b64 v[178:179], v50 offset:56
    ds_read_b128 v[168:171], v48 offset:32
    ds_read_b64 v[148:149], v53 offset:64
    ds_read_b64 v[180:181], v50 offset:88
    ds_read_b128 v[172:175], v48 offset:48
    ds_read_b64 v[150:151], v53 offset:96
    ds_read_b64 v[182:183], v50 offset:120
    v_mov_b32 v88, 0
    v_mov_b32 v89, 0
    v_mov_b32 v90, 0
    v_mov_b32 v91, 0
    v_mov_b32 v92, 0
    v_mov_b32 v93, 0
    v_mov_b32 v94, 0
    v_mov_b32 v95, 0
    v_mov_b32 v100, 0
    v_mov_b32 v101, 0
    v_mov_b32 v102, 0
    v_mov_b32 v103, 0
    s_lshl_b32 s14, s3, 11
    s_add_u32 s43, s14, 1048576
    s_add_u32 s14, s14, 16384
    s_add_u32 s15, s14, 8192
    s_lshl_b32 s11, s8, 13
    s_add_u32 s43, s43, s11
    s_lshr_b32 s13, s8, 3
    s_lshl_b32 s13, s13, 7
    s_add_u32 s13, s13, 4096
    s_add_u32 s50, s13, 64
    s_mov_b32 s51, 0
    s_branch L_kg
.p2align 6
L_kg:
    v_add_u32 v48, 256, v48
    v_add_u32 v50, 512, v50
    v_add_u32 v53, 512, v53
    s_waitcnt lgkmcnt(6)
    v_mul_f32 v201, v161, v45
    v_mul_f32 v204, v161, v44
    v_mul_f32 v213, v165, v45
    v_mul_f32 v216, v165, v44
    v_mul_f32 v200, v160, v45
    v_mul_f32 v203, v160, v44
    v_mul_f32 v212, v164, v45
    v_mul_f32 v215, v164, v44
    v_exp_f32 v200, v200
    v_exp_f32 v203, v203
    v_exp_f32 v212, v212
    v_exp_f32 v215, v215
    v_cos_f32 v202, v201
    v_cos_f32 v205, v204
    v_cos_f32 v214, v213
    v_cos_f32 v217, v216
    v_sin_f32 v201, v201
    v_sin_f32 v204, v204
    v_sin_f32 v213, v213
    v_sin_f32 v216, v216
    v_mul_f32 v202, v202, v200
    v_mul_f32 v205, v205, v203
    v_mul_f32 v214, v214, v212
    v_mul_f32 v217, v217, v215
    v_mul_f32 v201, v201, v200
    v_mul_f32 v204, v204, v203
    v_mul_f32 v213, v213, v212
    v_mul_f32 v216, v216, v215
    v_mul_f32 v206, v202, v144
    v_mul_f32 v207, v201, v144
    v_mul_f32 v218, v214, v146
    v_mul_f32 v219, v213, v146
    v_mul_f32 v208, v205, v162
    v_mul_f32 v209, v204, v162
    v_mul_f32 v220, v217, v166
    v_mul_f32 v221, v216, v166
    v_fma_f32 v206, -v201, v145, v206
    v_fmac_f32 v207, v202, v145
    v_fma_f32 v218, -v213, v147, v218
    v_fmac_f32 v219, v214, v147
    v_fma_f32 v208, -v204, v163, v208
    v_fmac_f32 v209, v205, v163
    v_fma_f32 v220, -v216, v167, v220
    v_fmac_f32 v221, v217, v167
    v_cvt_pk_bf16_f32 v188, v202, v201
    v_cvt_pk_bf16_f32 v189, v214, v213
    ds_read_b128 v[160:163], v48 offset:0
    ds_read_b64 v[144:145], v53 offset:0
    ds_read_b128 v[164:167], v48 offset:16
    ds_read_b64 v[146:147], v53 offset:32
    v_mul_f32 v210, v206, v176
    v_mul_f32 v211, v207, v176
    v_mul_f32 v222, v218, v178
    v_mul_f32 v223, v219, v178
    v_fma_f32 v210, -v207, v177, v210
    v_fmac_f32 v211, v206, v177
    v_fma_f32 v222, -v219, v179, v222
    v_fmac_f32 v223, v218, v179
    v_cvt_pk_bf16_f32 v192, v206, v207
    v_cvt_pk_bf16_f32 v184, v208, -v209
    v_cvt_pk_bf16_f32 v193, v218, v219
    v_cvt_pk_bf16_f32 v185, v220, -v221
    ds_read_b64 v[176:177], v50 offset:24
    ds_read_b64 v[178:179], v50 offset:56
    v_cvt_pk_bf16_f32 v196, v210, v211
    v_cvt_pk_bf16_f32 v197, v222, v223
    s_waitcnt lgkmcnt(6)
    s_lshl_b32 s11, s3, 2
    s_add_u32 s11, s11, s51
    s_cmp_lg_u32 s11, 7
    s_cbranch_scc1 L_nxp
    s_load_dwordx16 s[16:31], s[40:41], s13 glc
    s_load_dwordx16 s[68:83], s[40:41], s50 glc
L_nxp:
    v_mul_f32 v225, v169, v45
    v_mul_f32 v228, v169, v44
    v_mul_f32 v237, v173, v45
    v_mul_f32 v240, v173, v44
    v_mul_f32 v224, v168, v45
    v_mul_f32 v227, v168, v44
    v_mul_f32 v236, v172, v45
    v_mul_f32 v239, v172, v44
    v_exp_f32 v224, v224
    v_exp_f32 v227, v227
    v_exp_f32 v236, v236
    v_exp_f32 v239, v239
    v_cos_f32 v226, v225
    v_cos_f32 v229, v228
    v_cos_f32 v238, v237
    v_cos_f32 v241, v240
    v_sin_f32 v225, v225
    v_sin_f32 v228, v228
    v_sin_f32 v237, v237
    v_sin_f32 v240, v240
    v_mul_f32 v226, v226, v224
    v_mul_f32 v229, v229, v227
    v_mul_f32 v238, v238, v236
    v_mul_f32 v241, v241, v239
    v_mul_f32 v225, v225, v224
    v_mul_f32 v228, v228, v227
    v_mul_f32 v237, v237, v236
    v_mul_f32 v240, v240, v239
    v_mul_f32 v230, v226, v148
    v_mul_f32 v231, v225, v148
    v_mul_f32 v242, v238, v150
    v_mul_f32 v243, v237, v150
    v_mul_f32 v232, v229, v170
    v_mul_f32 v233, v228, v170
    v_mul_f32 v244, v241, v174
    v_mul_f32 v245, v240, v174
    v_fma_f32 v230, -v225, v149, v230
    v_fmac_f32 v231, v226, v149
    v_fma_f32 v242, -v237, v151, v242
    v_fmac_f32 v243, v238, v151
    v_fma_f32 v232, -v228, v171, v232
    v_fmac_f32 v233, v229, v171
    v_fma_f32 v244, -v240, v175, v244
    v_fmac_f32 v245, v241, v175
    v_cvt_pk_bf16_f32 v190, v226, v225
    v_cvt_pk_bf16_f32 v191, v238, v237
    ds_read_b128 v[168:171], v48 offset:32
    ds_read_b64 v[148:149], v53 offset:64
    ds_read_b128 v[172:175], v48 offset:48
    ds_read_b64 v[150:151], v53 offset:96
    v_mul_f32 v234, v230, v180
    v_mul_f32 v235, v231, v180
    v_mul_f32 v246, v242, v182
    v_mul_f32 v247, v243, v182
    v_fma_f32 v234, -v231, v181, v234
    v_fmac_f32 v235, v230, v181
    v_fma_f32 v246, -v243, v183, v246
    v_fmac_f32 v247, v242, v183
    v_cvt_pk_bf16_f32 v194, v230, v231
    v_cvt_pk_bf16_f32 v186, v232, -v233
    v_cvt_pk_bf16_f32 v195, v242, v243
    v_cvt_pk_bf16_f32 v187, v244, -v245
    ds_read_b64 v[180:181], v50 offset:88
    ds_read_b64 v[182:183], v50 offset:120
    v_cvt_pk_bf16_f32 v198, v234, v235
    v_cvt_pk_bf16_f32 v199, v246, v247
    s_add_u32 s51, s51, 1
    v_mfma_f32_16x16x32_bf16 v[88:91], v[188:191], v[184:187], v[88:91]
    v_mfma_f32_16x16x32_bf16 v[92:95], v[192:195], v[184:187], v[92:95]
    v_mfma_f32_16x16x32_bf16 v[100:103], v[196:199], v[184:187], v[100:103]
    s_cmp_lg_u32 s51, 1
    s_cbranch_scc1 L_kg2
    s_waitcnt vmcnt(1)
    s_setprio 3
    v_mov_b32 v3, 0
    s_mov_b64 exec, 1
    buffer_store_dword v26, v3, s[56:59], s48 offen sc1
    s_mov_b64 exec, -1
    s_setprio 3
L_kg2:
    s_cmp_lg_u32 s51, 2
    s_cbranch_scc1 L_kg4
    s_setprio 0
L_kg4:
    s_cmp_lt_u32 s51, 4
    s_cbranch_scc1 L_kg
    s_setprio 0
    s_nop 7
    s_cmp_lg_u32 s10, 0
    s_cbranch_scc1 L_x1
    ds_write_b128 v51, v[100:103]
    ds_write_b64 v51, v[94:95] offset:1024
    s_branch L_x2
L_x1:
    ds_write_b128 v51, v[88:91]
    ds_write_b64 v51, v[92:93] offset:1024
L_x2:
    s_lshl_b32 s11, s9, 3
    s_add_u32 s11, s11, 64512
    v_mov_b32 v10, s11
    v_mov_b32 v11, s42
    v_mov_b32 v248, 0
    v_mov_b32 v249, 0
    v_mov_b32 v250, 0
    s_waitcnt lgkmcnt(0)
    s_cmp_lg_u32 s3, 1
    s_cbranch_scc1 L_nxc
    s_mov_b64 vcc, s[16:17]
    s_or_b64 vcc, vcc, s[18:19]
    s_and_b64 s[16:17], s[16:17], s[18:19]
    s_or_b64 vcc, vcc, s[20:21]
    s_and_b64 s[16:17], s[16:17], s[20:21]
    s_or_b64 vcc, vcc, s[22:23]
    s_and_b64 s[16:17], s[16:17], s[22:23]
    s_or_b64 vcc, vcc, s[24:25]
    s_and_b64 s[16:17], s[16:17], s[24:25]
    s_or_b64 vcc, vcc, s[26:27]
    s_and_b64 s[16:17], s[16:17], s[26:27]
    s_or_b64 vcc, vcc, s[28:29]
    s_and_b64 s[16:17], s[16:17], s[28:29]
    s_or_b64 vcc, vcc, s[30:31]
    s_and_b64 s[16:17], s[16:17], s[30:31]
    s_or_b64 vcc, vcc, s[68:69]
    s_and_b64 s[16:17], s[16:17], s[68:69]
    s_or_b64 vcc, vcc, s[70:71]
    s_and_b64 s[16:17], s[16:17], s[70:71]
    s_or_b64 vcc, vcc, s[72:73]
    s_and_b64 s[16:17], s[16:17], s[72:73]
    s_or_b64 vcc, vcc, s[74:75]
    s_and_b64 s[16:17], s[16:17], s[74:75]
    s_or_b64 vcc, vcc, s[76:77]
    s_and_b64 s[16:17], s[16:17], s[76:77]
    s_or_b64 vcc, vcc, s[78:79]
    s_and_b64 s[16:17], s[16:17], s[78:79]
    s_or_b64 vcc, vcc, s[80:81]
    s_and_b64 s[16:17], s[16:17], s[80:81]
    s_or_b64 vcc, vcc, s[82:83]
    s_and_b64 s[16:17], s[16:17], s[82:83]
    s_or_b32 vcc_lo, vcc_lo, vcc_hi
    s_and_b32 s16, s16, s17
    s_xor_b32 vcc_lo, vcc_lo, s49
    s_xor_b32 s16, s16, s49
    s_or_b32 s16, s16, vcc_lo
    s_cbranch_scc1 L_slow4
L_ret4:
L_nxc:
    s_barrier
    s_setprio 3
    buffer_load_dwordx4 v[104:107], v4, s[56:59], s43 offen offset:0 sc1
    buffer_load_dwordx4 v[108:111], v4, s[56:59], s43 offen offset:1024 sc1
    buffer_load_dwordx4 v[120:123], v4, s[56:59], s14 offen offset:0 sc1
    buffer_load_dwordx4 v[124:127], v4, s[56:59], s15 offen offset:0 sc1
    buffer_load_dwordx4 v[128:131], v4, s[56:59], s14 offen offset:1024 sc1
    buffer_load_dwordx4 v[132:135], v4, s[56:59], s15 offen offset:1024 sc1
    s_setprio 0
    ds_read_b128 v[160:163], v52
    ds_read_b64 v[164:165], v52 offset:1024
    ds_read_b64 v[166:167], v10
    s_cmp_lg_u32 s10, 0
    s_cbranch_scc1 L_x3
    s_waitcnt lgkmcnt(0)
    v_add_f32 v160, v160, v88
    v_add_f32 v161, v161, v89
    v_add_f32 v162, v162, v90
    v_add_f32 v163, v163, v91
    v_add_f32 v164, v164, v92
    v_add_f32 v165, v165, v93
    v_add_f32 v251, v166, v167
    v_add_f32 v251, v251, v25
    ds_write_b32 v32, v160
    ds_write_b32 v33, v161
    ds_write_b32 v34, v162
    ds_write_b32 v35, v163
    ds_write_b32 v36, v164
    ds_write_b32 v37, v165
    v_subrev_u32 v11, 12, v11
    ds_write_b128 v11, v[248:251]
    s_branch L_x4
L_x3:
    s_waitcnt lgkmcnt(0)
    v_add_f32 v160, v160, v100
    v_add_f32 v161, v161, v101
    v_add_f32 v162, v162, v102
    v_add_f32 v163, v163, v103
    v_add_f32 v164, v164, v94
    v_add_f32 v165, v165, v95
    ds_write_b32 v40, v160 offset:0
    ds_write_b32 v40, v161 offset:32
    ds_write_b32 v40, v162 offset:64
    ds_write_b32 v40, v163 offset:96
    ds_write_b32 v38, v164
    ds_write_b32 v39, v165
L_x4:
    s_waitcnt lgkmcnt(0)
    s_barrier
    ds_read_b32 v160, v64 offset:0
    ds_read_b32 v161, v65 offset:4
    ds_read_b32 v162, v66 offset:8
    ds_read_b32 v163, v67 offset:12
    ds_read_b32 v164, v68 offset:16
    ds_read_b32 v165, v69 offset:20
    ds_read_b32 v166, v70 offset:24
    ds_read_b32 v167, v71 offset:28
    ds_read_b32 v168, v72 offset:32
    ds_read_b32 v169, v73 offset:36
    ds_read_b32 v170, v74 offset:40
    ds_read_b32 v176, v64 offset:2816
    ds_read_b32 v177, v65 offset:2820
    ds_read_b32 v178, v66 offset:2824
    ds_read_b32 v179, v67 offset:2828
    ds_read_b32 v180, v68 offset:2832
    ds_read_b32 v181, v69 offset:2836
    ds_read_b32 v182, v70 offset:2840
    ds_read_b32 v183, v71 offset:2844
    ds_read_b32 v184, v72 offset:2848
    ds_read_b32 v185, v73 offset:2852
    ds_read_b32 v186, v74 offset:2856
    v_mov_b32 v88, 0
    v_mov_b32 v89, 0
    v_mov_b32 v90, 0
    v_mov_b32 v91, 0
    v_bfe_u32 v10, v2, 1, 3
    v_mul_u32_u24 v10, 4160, v10
    v_and_b32 v11, 1, v2
    v_lshl_add_u32 v10, v11, 4, v10
    v_add_u32 v10, 4096, v10
    v_lshrrev_b32 v11, 5, v2
    v_mul_u32_u24 v11, 4608, v11
    v_and_b32 v27, 31, v2
    v_min_u32 v27, 29, v27
    v_lshl_add_u32 v11, v27, 4, v11
    s_waitcnt vmcnt(0)
    v_xor_b32 v3, v121, v26
    v_bitop3_b32 v3, v3, v123, v26 bitop3:0xf6
    v_bitop3_b32 v3, v3, v125, v26 bitop3:0xf6
    v_bitop3_b32 v3, v3, v127, v26 bitop3:0xf6
    v_bitop3_b32 v3, v3, v129, v26 bitop3:0xf6
    v_bitop3_b32 v3, v3, v131, v26 bitop3:0xf6
    v_bitop3_b32 v3, v3, v133, v26 bitop3:0xf6
    v_bitop3_b32 v3, v3, v135, v26 bitop3:0xf6
    v_cmp_ne_u32 vcc, 0, v3
    s_nop 0
    s_cbranch_vccnz L_slow5
L_ret5:
    ds_write_b128 v10, v[88:91]
    ds_write_b128 v11, v[88:91] offset:33280
    v_and_b32 v224, 0xffff0000, v120
    v_rcp_f32 v224, v224
    v_lshlrev_b32 v225, 16, v120
    v_lshlrev_b32 v144, 16, v104
    v_and_b32 v145, 0xffff0000, v104
    v_and_b32 v226, 0xffff0000, v122
    v_rcp_f32 v226, v226
    v_lshlrev_b32 v227, 16, v122
    v_lshlrev_b32 v146, 16, v105
    v_and_b32 v147, 0xffff0000, v105
    s_waitcnt lgkmcnt(13)
    v_cvt_pk_bf16_f32 v192, v167, v166
    v_cvt_pk_bf16_f32 v193, v165, v164
    v_cvt_pk_bf16_f32 v194, v163, v162
    v_cvt_pk_bf16_f32 v195, v161, v160
    ds_write_b128 v75, v[192:195] offset:0
    v_and_b32 v228, 0xffff0000, v124
    v_rcp_f32 v228, v228
    v_lshlrev_b32 v229, 16, v124
    v_lshlrev_b32 v148, 16, v106
    v_and_b32 v149, 0xffff0000, v106
    v_and_b32 v230, 0xffff0000, v126
    v_rcp_f32 v230, v230
    v_lshlrev_b32 v231, 16, v126
    v_lshlrev_b32 v150, 16, v107
    v_and_b32 v151, 0xffff0000, v107
    v_cvt_pk_bf16_f32 v196, v168, v167
    v_cvt_pk_bf16_f32 v197, v166, v165
    v_cvt_pk_bf16_f32 v198, v164, v163
    v_cvt_pk_bf16_f32 v199, v162, v161
    ds_write_b128 v75, v[196:199] offset:4160
    v_and_b32 v232, 0xffff0000, v128
    v_rcp_f32 v232, v232
    v_lshlrev_b32 v233, 16, v128
    v_lshlrev_b32 v152, 16, v108
    v_and_b32 v153, 0xffff0000, v108
    v_and_b32 v234, 0xffff0000, v130
    v_rcp_f32 v234, v234
    v_lshlrev_b32 v235, 16, v130
    v_lshlrev_b32 v154, 16, v109
    v_and_b32 v155, 0xffff0000, v109
    v_cvt_pk_bf16_f32 v200, v169, v168
    v_cvt_pk_bf16_f32 v201, v167, v166
    v_cvt_pk_bf16_f32 v202, v165, v164
    v_cvt_pk_bf16_f32 v203, v163, v162
    ds_write_b128 v75, v[200:203] offset:8320
    v_and_b32 v236, 0xffff0000, v132
    v_rcp_f32 v236, v236
    v_lshlrev_b32 v237, 16, v132
    v_lshlrev_b32 v156, 16, v110
    v_and_b32 v157, 0xffff0000, v110
    v_and_b32 v238, 0xffff0000, v134
    v_rcp_f32 v238, v238
    v_lshlrev_b32 v239, 16, v134
    v_lshlrev_b32 v158, 16, v111
    v_and_b32 v159, 0xffff0000, v111
    v_cvt_pk_bf16_f32 v204, v170, v169
    v_cvt_pk_bf16_f32 v205, v168, v167
    v_cvt_pk_bf16_f32 v206, v166, v165
    v_cvt_pk_bf16_f32 v207, v164, v163
    ds_write_b128 v75, v[204:207] offset:12480
    v_mul_f32 v225, v225, v224
    v_mul_f32 v227, v227, v226
    v_mul_f32 v229, v229, v228
    v_mul_f32 v231, v231, v230
    v_mul_f32 v233, v233, v232
    v_mul_f32 v235, v235, v234
    v_mul_f32 v237, v237, v236
    v_mul_f32 v239, v239, v238
    v_fma_f32 v240, v144, v224, -v225
    v_fma_f32 v241, v145, v224, -v225
    s_waitcnt lgkmcnt(6)
    v_cvt_pk_bf16_f32 v208, v183, v182
    v_cvt_pk_bf16_f32 v209, v181, v180
    v_cvt_pk_bf16_f32 v210, v179, v178
    v_cvt_pk_bf16_f32 v211, v177, v176
    ds_write_b128 v75, v[208:211] offset:16640
    v_fma_f32 v242, v146, v226, -v227
    v_fma_f32 v243, v147, v226, -v227
    v_fma_f32 v244, v148, v228, -v229
    v_fma_f32 v245, v149, v228, -v229
    v_fma_f32 v246, v150, v230, -v231
    v_fma_f32 v247, v151, v230, -v231
    v_cvt_pk_bf16_f32 v96, v240, v242
    v_cvt_pk_bf16_f32 v97, v244, v246
    ds_write_b64 v81, v[96:97] offset:0
    v_cvt_pk_bf16_f32 v100, v241, v243
    v_cvt_pk_bf16_f32 v212, v184, v183
    v_cvt_pk_bf16_f32 v213, v182, v181
    v_cvt_pk_bf16_f32 v214, v180, v179
    v_cvt_pk_bf16_f32 v215, v178, v177
    ds_write_b128 v75, v[212:215] offset:20800
    v_cvt_pk_bf16_f32 v101, v245, v247
    ds_write_b64 v81, v[100:101] offset:4608
    v_fma_f32 v248, v152, v232, -v233
    v_fma_f32 v249, v153, v232, -v233
    v_fma_f32 v250, v154, v234, -v235
    v_fma_f32 v251, v155, v234, -v235
    v_fma_f32 v252, v156, v236, -v237
    v_fma_f32 v253, v157, v236, -v237
    v_fma_f32 v254, v158, v238, -v239
    v_fma_f32 v255, v159, v238, -v239
    v_cvt_pk_bf16_f32 v216, v185, v184
    v_cvt_pk_bf16_f32 v217, v183, v182
    v_cvt_pk_bf16_f32 v218, v181, v180
    v_cvt_pk_bf16_f32 v219, v179, v178
    ds_write_b128 v75, v[216:219] offset:24960
    v_cvt_pk_bf16_f32 v98, v248, v250
    v_cvt_pk_bf16_f32 v99, v252, v254
    ds_write_b64 v81, v[98:99] offset:512
    v_cvt_pk_bf16_f32 v102, v249, v251
    v_cvt_pk_bf16_f32 v103, v253, v255
    ds_write_b64 v81, v[102:103] offset:5120
    v_cvt_pk_bf16_f32 v220, v186, v185
    v_cvt_pk_bf16_f32 v221, v184, v183
    v_cvt_pk_bf16_f32 v222, v182, v181
    v_cvt_pk_bf16_f32 v223, v180, v179
    ds_write_b128 v75, v[220:223] offset:29120
    s_waitcnt lgkmcnt(0)
    s_barrier
    s_setprio 2
    ds_read_b128 v[224:227], v77 offset:448
    ds_read_b64 v[160:161], v76 offset:3776
    ds_read_b64 v[162:163], v76 offset:3784
    ds_read_b128 v[228:231], v77 offset:960
    ds_read_b64 v[164:165], v76 offset:3264
    ds_read_b64 v[166:167], v76 offset:3272
    ds_read_b128 v[232:235], v77 offset:1472
    ds_read_b64 v[168:169], v76 offset:2752
    ds_read_b64 v[170:171], v76 offset:2760
    ds_read_b128 v[236:239], v77 offset:1984
    ds_read_b64 v[172:173], v76 offset:2240
    ds_read_b64 v[174:175], v76 offset:2248
    ds_read_b128 v[240:243], v77 offset:2496
    ds_read_b64 v[176:177], v76 offset:1728
    ds_read_b64 v[178:179], v76 offset:1736
    ds_read_b128 v[244:247], v77 offset:3008
    ds_read_b64 v[180:181], v76 offset:1216
    ds_read_b64 v[182:183], v76 offset:1224
    ds_read_b128 v[248:251], v77 offset:3520
    ds_read_b64 v[184:185], v76 offset:704
    ds_read_b64 v[186:187], v76 offset:712
    ds_read_b128 v[252:255], v77 offset:4032
    ds_read_b64 v[188:189], v76 offset:192
    ds_read_b64 v[190:191], v76 offset:200
    s_waitcnt lgkmcnt(15)
    v_mfma_f32_16x16x32_bf16 v[32:35], v[160:163], v[224:227], 0
    s_waitcnt lgkmcnt(15)
    v_mfma_f32_16x16x32_bf16 v[36:39], v[160:163], v[228:231], 0
    v_mfma_f32_16x16x32_bf16 v[40:43], v[164:167], v[228:231], 0
    v_mfma_f32_16x16x32_bf16 v[36:39], v[164:167], v[224:227], v[36:39]
    s_waitcnt lgkmcnt(15)
    v_mfma_f32_16x16x32_bf16 v[40:43], v[160:163], v[232:235], v[40:43]
    v_mfma_f32_16x16x32_bf16 v[44:47], v[164:167], v[232:235], 0
    v_mfma_f32_16x16x32_bf16 v[48:51], v[168:171], v[232:235], 0
    v_mfma_f32_16x16x32_bf16 v[40:43], v[168:171], v[224:227], v[40:43]
    v_mfma_f32_16x16x32_bf16 v[44:47], v[168:171], v[228:231], v[44:47]
    s_waitcnt lgkmcnt(12)
    v_mfma_f32_16x16x32_bf16 v[44:47], v[160:163], v[236:239], v[44:47]
    v_mfma_f32_16x16x32_bf16 v[48:51], v[164:167], v[236:239], v[48:51]
    v_mfma_f32_16x16x32_bf16 v[52:55], v[168:171], v[236:239], 0
    v_mfma_f32_16x16x32_bf16 v[56:59], v[172:175], v[236:239], 0
    v_mfma_f32_16x16x32_bf16 v[44:47], v[172:175], v[224:227], v[44:47]
    v_mfma_f32_16x16x32_bf16 v[48:51], v[172:175], v[228:231], v[48:51]
    v_mfma_f32_16x16x32_bf16 v[52:55], v[172:175], v[232:235], v[52:55]
    s_waitcnt lgkmcnt(9)
    v_mfma_f32_16x16x32_bf16 v[48:51], v[160:163], v[240:243], v[48:51]
    ds_read_b128 v[88:91], v77 offset:384
    ds_read_b64 v[192:193], v76 offset:3712
    v_mfma_f32_16x16x32_bf16 v[52:55], v[164:167], v[240:243], v[52:55]
    ds_read_b64 v[194:195], v76 offset:3720
    ds_read_b128 v[92:95], v77 offset:896
    v_mfma_f32_16x16x32_bf16 v[56:59], v[168:171], v[240:243], v[56:59]
    ds_read_b64 v[196:197], v76 offset:3200
    ds_read_b64 v[198:199], v76 offset:3208
    v_mfma_f32_16x16x32_bf16 v[60:63], v[172:175], v[240:243], 0
    ds_read_b128 v[96:99], v77 offset:1408
    ds_read_b64 v[200:201], v76 offset:2688
    v_mfma_f32_16x16x32_bf16 v[48:51], v[176:179], v[224:227], v[48:51]
    ds_read_b64 v[202:203], v76 offset:2696
    ds_read_b128 v[100:103], v77 offset:1920
    v_mfma_f32_16x16x32_bf16 v[52:55], v[176:179], v[228:231], v[52:55]
    ds_read_b64 v[204:205], v76 offset:2176
    ds_read_b64 v[206:207], v76 offset:2184
    v_mfma_f32_16x16x32_bf16 v[56:59], v[176:179], v[232:235], v[56:59]
    ds_read_b128 v[104:107], v77 offset:2432
    ds_read_b64 v[208:209], v76 offset:1664
    v_mfma_f32_16x16x32_bf16 v[60:63], v[176:179], v[236:239], v[60:63]
    ds_read_b64 v[210:211], v76 offset:1672
    ds_read_b128 v[108:111], v77 offset:2944
    s_waitcnt lgkmcnt(15)
    v_mfma_f32_16x16x32_bf16 v[52:55], v[160:163], v[244:247], v[52:55]
    ds_read_b64 v[212:213], v76 offset:1152
    ds_read_b64 v[214:215], v76 offset:1160
    v_mfma_f32_16x16x32_bf16 v[56:59], v[164:167], v[244:247], v[56:59]
    ds_read_b128 v[112:115], v77 offset:3456
    ds_read_b64 v[216:217], v76 offset:640
    v_mfma_f32_16x16x32_bf16 v[60:63], v[168:171], v[244:247], v[60:63]
    ds_read_b64 v[218:219], v76 offset:648
    ds_read_b128 v[116:119], v77 offset:3968
    v_mfma_f32_16x16x32_bf16 v[52:55], v[180:183], v[224:227], v[52:55]
    ds_read_b64 v[220:221], v76 offset:128
    ds_read_b64 v[222:223], v76 offset:136
    v_mfma_f32_16x16x32_bf16 v[56:59], v[180:183], v[228:231], v[56:59]
    v_mfma_f32_16x16x32_bf16 v[60:63], v[180:183], v[232:235], v[60:63]
    s_waitcnt lgkmcnt(15)
    v_mfma_f32_16x16x32_bf16 v[56:59], v[160:163], v[248:251], v[56:59]
    v_mfma_f32_16x16x32_bf16 v[60:63], v[164:167], v[248:251], v[60:63]
    v_mfma_f32_16x16x32_bf16 v[56:59], v[184:187], v[224:227], v[56:59]
    v_mfma_f32_16x16x32_bf16 v[60:63], v[184:187], v[228:231], v[60:63]
    s_waitcnt lgkmcnt(15)
    v_mfma_f32_16x16x32_bf16 v[60:63], v[160:163], v[252:255], v[60:63]
    v_mfma_f32_16x16x32_bf16 v[60:63], v[188:191], v[224:227], v[60:63]
    s_waitcnt lgkmcnt(0)
    v_mfma_f32_16x16x32_bf16 v[32:35], v[192:195], v[88:91], v[32:35]
    ds_read_b128 v[224:227], v77 offset:320
    v_mfma_f32_16x16x32_bf16 v[36:39], v[192:195], v[92:95], v[36:39]
    ds_read_b64 v[160:161], v76 offset:3648
    v_mfma_f32_16x16x32_bf16 v[40:43], v[196:199], v[92:95], v[40:43]
    ds_read_b64 v[162:163], v76 offset:3656
    v_mfma_f32_16x16x32_bf16 v[36:39], v[196:199], v[88:91], v[36:39]
    ds_read_b128 v[228:231], v77 offset:832
    v_mfma_f32_16x16x32_bf16 v[40:43], v[192:195], v[96:99], v[40:43]
    ds_read_b64 v[164:165], v76 offset:3136
    v_mfma_f32_16x16x32_bf16 v[44:47], v[196:199], v[96:99], v[44:47]
    ds_read_b64 v[166:167], v76 offset:3144
    v_mfma_f32_16x16x32_bf16 v[48:51], v[200:203], v[96:99], v[48:51]
    ds_read_b128 v[232:235], v77 offset:1344
    v_mfma_f32_16x16x32_bf16 v[40:43], v[200:203], v[88:91], v[40:43]
    ds_read_b64 v[168:169], v76 offset:2624
    v_mfma_f32_16x16x32_bf16 v[44:47], v[200:203], v[92:95], v[44:47]
    ds_read_b64 v[170:171], v76 offset:2632
    v_mfma_f32_16x16x32_bf16 v[44:47], v[192:195], v[100:103], v[44:47]
    ds_read_b128 v[236:239], v77 offset:1856
    v_mfma_f32_16x16x32_bf16 v[48:51], v[196:199], v[100:103], v[48:51]
    ds_read_b64 v[172:173], v76 offset:2112
    v_mfma_f32_16x16x32_bf16 v[52:55], v[200:203], v[100:103], v[52:55]
    ds_read_b64 v[174:175], v76 offset:2120
    v_mfma_f32_16x16x32_bf16 v[56:59], v[204:207], v[100:103], v[56:59]
    ds_read_b128 v[240:243], v77 offset:2368
    v_mfma_f32_16x16x32_bf16 v[44:47], v[204:207], v[88:91], v[44:47]
    ds_read_b64 v[176:177], v76 offset:1600
    v_mfma_f32_16x16x32_bf16 v[48:51], v[204:207], v[92:95], v[48:51]
    ds_read_b64 v[178:179], v76 offset:1608
    v_mfma_f32_16x16x32_bf16 v[52:55], v[204:207], v[96:99], v[52:55]
    ds_read_b128 v[244:247], v77 offset:2880
    v_mfma_f32_16x16x32_bf16 v[48:51], v[192:195], v[104:107], v[48:51]
    ds_read_b64 v[180:181], v76 offset:1088
    v_mfma_f32_16x16x32_bf16 v[52:55], v[196:199], v[104:107], v[52:55]
    ds_read_b64 v[182:183], v76 offset:1096
    v_mfma_f32_16x16x32_bf16 v[56:59], v[200:203], v[104:107], v[56:59]
    ds_read_b128 v[248:251], v77 offset:3392
    v_mfma_f32_16x16x32_bf16 v[60:63], v[204:207], v[104:107], v[60:63]
    ds_read_b64 v[184:185], v76 offset:576
    v_mfma_f32_16x16x32_bf16 v[48:51], v[208:211], v[88:91], v[48:51]
    ds_read_b64 v[186:187], v76 offset:584
    v_mfma_f32_16x16x32_bf16 v[52:55], v[208:211], v[92:95], v[52:55]
    ds_read_b128 v[252:255], v77 offset:3904
    v_mfma_f32_16x16x32_bf16 v[56:59], v[208:211], v[96:99], v[56:59]
    ds_read_b64 v[188:189], v76 offset:64
    v_mfma_f32_16x16x32_bf16 v[60:63], v[208:211], v[100:103], v[60:63]
    ds_read_b64 v[190:191], v76 offset:72
    v_mfma_f32_16x16x32_bf16 v[52:55], v[192:195], v[108:111], v[52:55]
    v_mfma_f32_16x16x32_bf16 v[56:59], v[196:199], v[108:111], v[56:59]
    v_mfma_f32_16x16x32_bf16 v[60:63], v[200:203], v[108:111], v[60:63]
    v_mfma_f32_16x16x32_bf16 v[52:55], v[212:215], v[88:91], v[52:55]
    v_mfma_f32_16x16x32_bf16 v[56:59], v[212:215], v[92:95], v[56:59]
    v_mfma_f32_16x16x32_bf16 v[60:63], v[212:215], v[96:99], v[60:63]
    v_mfma_f32_16x16x32_bf16 v[56:59], v[192:195], v[112:115], v[56:59]
    v_mfma_f32_16x16x32_bf16 v[60:63], v[196:199], v[112:115], v[60:63]
    v_mfma_f32_16x16x32_bf16 v[56:59], v[216:219], v[88:91], v[56:59]
    v_mfma_f32_16x16x32_bf16 v[60:63], v[216:219], v[92:95], v[60:63]
    v_mfma_f32_16x16x32_bf16 v[60:63], v[192:195], v[116:119], v[60:63]
    v_mfma_f32_16x16x32_bf16 v[60:63], v[220:223], v[88:91], v[60:63]
    s_waitcnt lgkmcnt(0)
    v_mfma_f32_16x16x32_bf16 v[32:35], v[160:163], v[224:227], v[32:35]
    ds_read_b128 v[88:91], v77 offset:256
    v_mfma_f32_16x16x32_bf16 v[36:39], v[160:163], v[228:231], v[36:39]
    ds_read_b64 v[192:193], v76 offset:3584
    v_mfma_f32_16x16x32_bf16 v[40:43], v[164:167], v[228:231], v[40:43]
    ds_read_b64 v[194:195], v76 offset:3592
    v_mfma_f32_16x16x32_bf16 v[36:39], v[164:167], v[224:227], v[36:39]
    ds_read_b128 v[92:95], v77 offset:768
    v_mfma_f32_16x16x32_bf16 v[40:43], v[160:163], v[232:235], v[40:43]
    ds_read_b64 v[196:197], v76 offset:3072
    v_mfma_f32_16x16x32_bf16 v[44:47], v[164:167], v[232:235], v[44:47]
    ds_read_b64 v[198:199], v76 offset:3080
    v_mfma_f32_16x16x32_bf16 v[48:51], v[168:171], v[232:235], v[48:51]
    ds_read_b128 v[96:99], v77 offset:1280
    v_mfma_f32_16x16x32_bf16 v[40:43], v[168:171], v[224:227], v[40:43]
    ds_read_b64 v[200:201], v76 offset:2560
    v_mfma_f32_16x16x32_bf16 v[44:47], v[168:171], v[228:231], v[44:47]
    ds_read_b64 v[202:203], v76 offset:2568
    v_mfma_f32_16x16x32_bf16 v[44:47], v[160:163], v[236:239], v[44:47]
    ds_read_b128 v[100:103], v77 offset:1792
    v_mfma_f32_16x16x32_bf16 v[48:51], v[164:167], v[236:239], v[48:51]
    ds_read_b64 v[204:205], v76 offset:2048
    v_mfma_f32_16x16x32_bf16 v[52:55], v[168:171], v[236:239], v[52:55]
    ds_read_b64 v[206:207], v76 offset:2056
    v_mfma_f32_16x16x32_bf16 v[56:59], v[172:175], v[236:239], v[56:59]
    ds_read_b128 v[104:107], v77 offset:2304
    v_mfma_f32_16x16x32_bf16 v[44:47], v[172:175], v[224:227], v[44:47]
    ds_read_b64 v[208:209], v76 offset:1536
    v_mfma_f32_16x16x32_bf16 v[48:51], v[172:175], v[228:231], v[48:51]
    ds_read_b64 v[210:211], v76 offset:1544
    v_mfma_f32_16x16x32_bf16 v[52:55], v[172:175], v[232:235], v[52:55]
    ds_read_b128 v[108:111], v77 offset:2816
    v_mfma_f32_16x16x32_bf16 v[48:51], v[160:163], v[240:243], v[48:51]
    ds_read_b64 v[212:213], v76 offset:1024
    v_mfma_f32_16x16x32_bf16 v[52:55], v[164:167], v[240:243], v[52:55]
    ds_read_b64 v[214:215], v76 offset:1032
    v_mfma_f32_16x16x32_bf16 v[56:59], v[168:171], v[240:243], v[56:59]
    ds_read_b128 v[112:115], v77 offset:3328
    v_mfma_f32_16x16x32_bf16 v[60:63], v[172:175], v[240:243], v[60:63]
    ds_read_b64 v[216:217], v76 offset:512
    v_mfma_f32_16x16x32_bf16 v[48:51], v[176:179], v[224:227], v[48:51]
    ds_read_b64 v[218:219], v76 offset:520
    v_mfma_f32_16x16x32_bf16 v[52:55], v[176:179], v[228:231], v[52:55]
    ds_read_b128 v[116:119], v77 offset:3840
    v_mfma_f32_16x16x32_bf16 v[56:59], v[176:179], v[232:235], v[56:59]
    ds_read_b64 v[220:221], v76 offset:0
    v_mfma_f32_16x16x32_bf16 v[60:63], v[176:179], v[236:239], v[60:63]
    ds_read_b64 v[222:223], v76 offset:8
    v_mfma_f32_16x16x32_bf16 v[52:55], v[160:163], v[244:247], v[52:55]
    v_mfma_f32_16x16x32_bf16 v[56:59], v[164:167], v[244:247], v[56:59]
    v_mfma_f32_16x16x32_bf16 v[60:63], v[168:171], v[244:247], v[60:63]
    v_mfma_f32_16x16x32_bf16 v[52:55], v[180:183], v[224:227], v[52:55]
    v_mfma_f32_16x16x32_bf16 v[56:59], v[180:183], v[228:231], v[56:59]
    v_mfma_f32_16x16x32_bf16 v[60:63], v[180:183], v[232:235], v[60:63]
    v_mfma_f32_16x16x32_bf16 v[56:59], v[160:163], v[248:251], v[56:59]
    v_mfma_f32_16x16x32_bf16 v[60:63], v[164:167], v[248:251], v[60:63]
    v_mfma_f32_16x16x32_bf16 v[56:59], v[184:187], v[224:227], v[56:59]
    v_mfma_f32_16x16x32_bf16 v[60:63], v[184:187], v[228:231], v[60:63]
    v_mfma_f32_16x16x32_bf16 v[60:63], v[160:163], v[252:255], v[60:63]
    v_mfma_f32_16x16x32_bf16 v[60:63], v[188:191], v[224:227], v[60:63]
    s_waitcnt lgkmcnt(0)
    v_mfma_f32_16x16x32_bf16 v[32:35], v[192:195], v[88:91], v[32:35]
    v_mfma_f32_16x16x32_bf16 v[36:39], v[192:195], v[92:95], v[36:39]
    v_mfma_f32_16x16x32_bf16 v[40:43], v[196:199], v[92:95], v[40:43]
    v_mfma_f32_16x16x32_bf16 v[36:39], v[196:199], v[88:91], v[36:39]
    v_mfma_f32_16x16x32_bf16 v[40:43], v[192:195], v[96:99], v[40:43]
    v_mfma_f32_16x16x32_bf16 v[44:47], v[196:199], v[96:99], v[44:47]
    v_mfma_f32_16x16x32_bf16 v[48:51], v[200:203], v[96:99], v[48:51]
    v_mfma_f32_16x16x32_bf16 v[40:43], v[200:203], v[88:91], v[40:43]
    v_mfma_f32_16x16x32_bf16 v[44:47], v[200:203], v[92:95], v[44:47]
    v_mfma_f32_16x16x32_bf16 v[44:47], v[192:195], v[100:103], v[44:47]
    v_mfma_f32_16x16x32_bf16 v[48:51], v[196:199], v[100:103], v[48:51]
    v_mfma_f32_16x16x32_bf16 v[52:55], v[200:203], v[100:103], v[52:55]
    v_mfma_f32_16x16x32_bf16 v[56:59], v[204:207], v[100:103], v[56:59]
    v_mfma_f32_16x16x32_bf16 v[44:47], v[204:207], v[88:91], v[44:47]
    v_mfma_f32_16x16x32_bf16 v[48:51], v[204:207], v[92:95], v[48:51]
    v_mfma_f32_16x16x32_bf16 v[52:55], v[204:207], v[96:99], v[52:55]
    v_mfma_f32_16x16x32_bf16 v[48:51], v[192:195], v[104:107], v[48:51]
    v_mfma_f32_16x16x32_bf16 v[52:55], v[196:199], v[104:107], v[52:55]
    v_mfma_f32_16x16x32_bf16 v[56:59], v[200:203], v[104:107], v[56:59]
    v_mfma_f32_16x16x32_bf16 v[60:63], v[204:207], v[104:107], v[60:63]
    v_mfma_f32_16x16x32_bf16 v[48:51], v[208:211], v[88:91], v[48:51]
    v_mfma_f32_16x16x32_bf16 v[52:55], v[208:211], v[92:95], v[52:55]
    v_mfma_f32_16x16x32_bf16 v[56:59], v[208:211], v[96:99], v[56:59]
    v_mfma_f32_16x16x32_bf16 v[60:63], v[208:211], v[100:103], v[60:63]
    v_mfma_f32_16x16x32_bf16 v[52:55], v[192:195], v[108:111], v[52:55]
    v_mfma_f32_16x16x32_bf16 v[56:59], v[196:199], v[108:111], v[56:59]
    v_mfma_f32_16x16x32_bf16 v[60:63], v[200:203], v[108:111], v[60:63]
    v_mfma_f32_16x16x32_bf16 v[52:55], v[212:215], v[88:91], v[52:55]
    v_mfma_f32_16x16x32_bf16 v[56:59], v[212:215], v[92:95], v[56:59]
    v_mfma_f32_16x16x32_bf16 v[60:63], v[212:215], v[96:99], v[60:63]
    v_mfma_f32_16x16x32_bf16 v[56:59], v[192:195], v[112:115], v[56:59]
    v_mfma_f32_16x16x32_bf16 v[60:63], v[196:199], v[112:115], v[60:63]
    v_mfma_f32_16x16x32_bf16 v[56:59], v[216:219], v[88:91], v[56:59]
    v_mfma_f32_16x16x32_bf16 v[60:63], v[216:219], v[92:95], v[60:63]
    v_mfma_f32_16x16x32_bf16 v[60:63], v[192:195], v[116:119], v[60:63]
    v_mfma_f32_16x16x32_bf16 v[60:63], v[220:223], v[88:91], v[60:63]
    ds_write_b128 v82, v[32:35] offset:0
    ds_write_b128 v82, v[36:39] offset:1024
    ds_write_b128 v82, v[40:43] offset:2048
    ds_write_b128 v82, v[44:47] offset:3072
    ds_write_b128 v82, v[48:51] offset:4096
    ds_write_b128 v82, v[52:55] offset:5120
    ds_write_b128 v82, v[56:59] offset:6144
    s_nop 0
    ds_write_b128 v82, v[60:63] offset:7168
    s_lshl_b32 s11, s8, 14
    s_lshl_b32 s12, s3, 11
    s_add_u32 s11, s11, s12
    s_add_u32 s14, s11, 5242880
    s_add_u32 s15, s14, 8192
    s_lshl_b32 s11, s8, 13
    s_add_u32 s11, s11, s12
    s_add_u32 s14, s11, 5242880
    s_lshl_b32 s12, s4, 2
    s_add_u32 s12, s12, s3
    s_lshl_b32 s12, s12, 7
    s_lshl_b32 s13, s5, 2
    s_add_u32 s12, s12, s13
    s_add_u32 s12, s12, 12288
    s_waitcnt lgkmcnt(0)
    s_barrier
    s_setprio 3
    ds_read_b128 v[160:163], v83 offset:0
    ds_read_b128 v[164:167], v83 offset:8192
    ds_read_b128 v[168:171], v83 offset:16384
    ds_read_b128 v[172:175], v83 offset:24576
    ds_read_b128 v[176:179], v83 offset:1024
    ds_read_b128 v[180:183], v83 offset:9216
    ds_read_b128 v[184:187], v83 offset:17408
    ds_read_b128 v[188:191], v83 offset:25600
    s_waitcnt lgkmcnt(4)
    v_add_f32 v160, v160, v164
    v_add_f32 v161, v161, v165
    v_add_f32 v162, v162, v166
    v_add_f32 v163, v163, v167
    v_add_f32 v160, v160, v144
    v_add_f32 v161, v161, v146
    v_add_f32 v162, v162, v148
    v_add_f32 v163, v163, v150
    v_add_f32 v168, v168, v172
    v_add_f32 v169, v169, v173
    v_add_f32 v170, v170, v174
    v_add_f32 v171, v171, v175
    v_add_f32 v168, v168, v145
    v_add_f32 v169, v169, v147
    v_add_f32 v170, v170, v149
    v_add_f32 v171, v171, v151
    v_cvt_pk_bf16_f32 v88, v160, v168
    v_cvt_pk_bf16_f32 v89, v161, v169
    v_cvt_pk_bf16_f32 v90, v162, v170
    v_cvt_pk_bf16_f32 v91, v163, v171
    buffer_store_dwordx4 v[88:91], v4, s[56:59], s14 offen offset:0 sc1
    s_waitcnt lgkmcnt(0)
    v_add_f32 v176, v176, v180
    v_add_f32 v177, v177, v181
    v_add_f32 v178, v178, v182
    v_add_f32 v179, v179, v183
    v_add_f32 v176, v176, v152
    v_add_f32 v177, v177, v154
    v_add_f32 v178, v178, v156
    v_add_f32 v179, v179, v158
    v_add_f32 v184, v184, v188
    v_add_f32 v185, v185, v189
    v_add_f32 v186, v186, v190
    v_add_f32 v187, v187, v191
    v_add_f32 v184, v184, v153
    v_add_f32 v185, v185, v155
    v_add_f32 v186, v186, v157
    v_add_f32 v187, v187, v159
    v_cvt_pk_bf16_f32 v96, v176, v184
    v_cvt_pk_bf16_f32 v97, v177, v185
    v_cvt_pk_bf16_f32 v98, v178, v186
    v_cvt_pk_bf16_f32 v99, v179, v187
    buffer_store_dwordx4 v[96:99], v4, s[56:59], s14 offen offset:1024 sc1
    s_waitcnt vmcnt(0)
    v_mov_b32 v3, 0
    s_mov_b64 exec, 1
    buffer_store_dword v26, v3, s[56:59], s12 offen sc1
    s_mov_b64 exec, -1
    s_cmp_lg_u32 s2, 0
    s_cbranch_scc1 L_end
    s_lshl_b32 s13, s3, 9
    s_add_u32 s13, s13, 8192
    s_add_u32 s50, s13, 128
    s_load_dwordx16 s[16:31], s[40:41], s13 glc
    s_load_dwordx16 s[68:83], s[40:41], s50 glc
    s_waitcnt lgkmcnt(0)
    s_mov_b64 vcc, s[16:17]
    s_or_b64 vcc, vcc, s[18:19]
    s_and_b64 s[16:17], s[16:17], s[18:19]
    s_or_b64 vcc, vcc, s[20:21]
    s_and_b64 s[16:17], s[16:17], s[20:21]
    s_or_b64 vcc, vcc, s[22:23]
    s_and_b64 s[16:17], s[16:17], s[22:23]
    s_or_b64 vcc, vcc, s[24:25]
    s_and_b64 s[16:17], s[16:17], s[24:25]
    s_or_b64 vcc, vcc, s[26:27]
    s_and_b64 s[16:17], s[16:17], s[26:27]
    s_or_b64 vcc, vcc, s[28:29]
    s_and_b64 s[16:17], s[16:17], s[28:29]
    s_or_b64 vcc, vcc, s[30:31]
    s_and_b64 s[16:17], s[16:17], s[30:31]
    s_or_b64 vcc, vcc, s[68:69]
    s_and_b64 s[16:17], s[16:17], s[68:69]
    s_or_b64 vcc, vcc, s[70:71]
    s_and_b64 s[16:17], s[16:17], s[70:71]
    s_or_b64 vcc, vcc, s[72:73]
    s_and_b64 s[16:17], s[16:17], s[72:73]
    s_or_b64 vcc, vcc, s[74:75]
    s_and_b64 s[16:17], s[16:17], s[74:75]
    s_or_b64 vcc, vcc, s[76:77]
    s_and_b64 s[16:17], s[16:17], s[76:77]
    s_or_b64 vcc, vcc, s[78:79]
    s_and_b64 s[16:17], s[16:17], s[78:79]
    s_or_b64 vcc, vcc, s[80:81]
    s_and_b64 s[16:17], s[16:17], s[80:81]
    s_or_b64 vcc, vcc, s[82:83]
    s_and_b64 s[16:17], s[16:17], s[82:83]
    s_or_b32 vcc_lo, vcc_lo, vcc_hi
    s_and_b32 s16, s16, s17
    s_xor_b32 vcc_lo, vcc_lo, s49
    s_xor_b32 s16, s16, s49
    s_or_b32 s16, s16, vcc_lo
    s_cbranch_scc1 L_slow6
L_ret6:
    s_add_u32 s13, s13, 256
    s_add_u32 s50, s13, 128
    s_load_dwordx16 s[16:31], s[40:41], s13 glc
    s_load_dwordx16 s[68:83], s[40:41], s50 glc
    s_waitcnt lgkmcnt(0)
    s_mov_b64 vcc, s[16:17]
    s_or_b64 vcc, vcc, s[18:19]
    s_and_b64 s[16:17], s[16:17], s[18:19]
    s_or_b64 vcc, vcc, s[20:21]
    s_and_b64 s[16:17], s[16:17], s[20:21]
    s_or_b64 vcc, vcc, s[22:23]
    s_and_b64 s[16:17], s[16:17], s[22:23]
    s_or_b64 vcc, vcc, s[24:25]
    s_and_b64 s[16:17], s[16:17], s[24:25]
    s_or_b64 vcc, vcc, s[26:27]
    s_and_b64 s[16:17], s[16:17], s[26:27]
    s_or_b64 vcc, vcc, s[28:29]
    s_and_b64 s[16:17], s[16:17], s[28:29]
    s_or_b64 vcc, vcc, s[30:31]
    s_and_b64 s[16:17], s[16:17], s[30:31]
    s_or_b64 vcc, vcc, s[68:69]
    s_and_b64 s[16:17], s[16:17], s[68:69]
    s_or_b64 vcc, vcc, s[70:71]
    s_and_b64 s[16:17], s[16:17], s[70:71]
    s_or_b64 vcc, vcc, s[72:73]
    s_and_b64 s[16:17], s[16:17], s[72:73]
    s_or_b64 vcc, vcc, s[74:75]
    s_and_b64 s[16:17], s[16:17], s[74:75]
    s_or_b64 vcc, vcc, s[76:77]
    s_and_b64 s[16:17], s[16:17], s[76:77]
    s_or_b64 vcc, vcc, s[78:79]
    s_and_b64 s[16:17], s[16:17], s[78:79]
    s_or_b64 vcc, vcc, s[80:81]
    s_and_b64 s[16:17], s[16:17], s[80:81]
    s_or_b64 vcc, vcc, s[82:83]
    s_and_b64 s[16:17], s[16:17], s[82:83]
    s_or_b32 vcc_lo, vcc_lo, vcc_hi
    s_and_b32 s16, s16, s17
    s_xor_b32 vcc_lo, vcc_lo, s49
    s_xor_b32 s16, s16, s49
    s_or_b32 s16, s16, vcc_lo
    s_cbranch_scc1 L_slow7
L_ret7:
    s_barrier
    s_cmp_lg_u32 s3, 0
    s_cbranch_scc1 L_end
    s_mov_b64 exec, 1
    buffer_store_dword v26, v3, s[56:59], 0 offen sc1
L_end:
    s_endpgm
L_slow0:
    s_mov_b32 s1, 0
L_spin0:
    s_sleep 4
    buffer_load_dwordx2 v[20:21], v30, s[56:59], s23 offen sc1
    s_waitcnt vmcnt(0)
    v_cmp_ne_u32 vcc, v21, v18
    s_nop 0
    s_cbranch_vccz L_ret0
    s_add_u32 s1, s1, 1
    s_cmp_lt_u32 s1, 65536
    s_cbranch_scc1 L_spin0
    s_branch L_ret0
L_slow1:
    s_mov_b32 s1, 0
L_spin1:
    s_load_dwordx16 s[68:83], s[40:41], s28 glc
    s_waitcnt lgkmcnt(0)
    s_mov_b64 vcc, s[68:69]
    s_or_b64 vcc, vcc, s[70:71]
    s_and_b64 s[68:69], s[68:69], s[70:71]
    s_or_b64 vcc, vcc, s[72:73]
    s_and_b64 s[68:69], s[68:69], s[72:73]
    s_or_b64 vcc, vcc, s[74:75]
    s_and_b64 s[68:69], s[68:69], s[74:75]
    s_or_b64 vcc, vcc, s[76:77]
    s_and_b64 s[68:69], s[68:69], s[76:77]
    s_or_b64 vcc, vcc, s[78:79]
    s_and_b64 s[68:69], s[68:69], s[78:79]
    s_or_b64 vcc, vcc, s[80:81]
    s_and_b64 s[68:69], s[68:69], s[80:81]
    s_or_b64 vcc, vcc, s[82:83]
    s_and_b64 s[68:69], s[68:69], s[82:83]
    s_or_b32 vcc_lo, vcc_lo, vcc_hi
    s_and_b32 s68, s68, s69
    s_xor_b32 vcc_lo, vcc_lo, s13
    s_xor_b32 s68, s68, s13
    s_or_b32 s68, s68, vcc_lo
    s_cbranch_scc0 L_out1
    s_sleep 8
    s_add_u32 s1, s1, 1
    s_cmp_lt_u32 s1, 65536
    s_cbranch_scc1 L_spin1
L_out1:
    s_branch L_ret1
L_slow3:
    s_mov_b32 s1, 0
L_spin3:
    s_load_dwordx16 s[68:83], s[40:41], s8 glc
    s_waitcnt lgkmcnt(0)
    s_mov_b64 vcc, s[68:69]
    s_or_b64 vcc, vcc, s[70:71]
    s_and_b64 s[68:69], s[68:69], s[70:71]
    s_or_b64 vcc, vcc, s[72:73]
    s_and_b64 s[68:69], s[68:69], s[72:73]
    s_or_b64 vcc, vcc, s[74:75]
    s_and_b64 s[68:69], s[68:69], s[74:75]
    s_or_b64 vcc, vcc, s[76:77]
    s_and_b64 s[68:69], s[68:69], s[76:77]
    s_or_b64 vcc, vcc, s[78:79]
    s_and_b64 s[68:69], s[68:69], s[78:79]
    s_or_b64 vcc, vcc, s[80:81]
    s_and_b64 s[68:69], s[68:69], s[80:81]
    s_or_b64 vcc, vcc, s[82:83]
    s_and_b64 s[68:69], s[68:69], s[82:83]
    s_or_b32 vcc_lo, vcc_lo, vcc_hi
    s_and_b32 s68, s68, s69
    s_xor_b32 vcc_lo, vcc_lo, s13
    s_xor_b32 s68, s68, s13
    s_or_b32 s68, s68, vcc_lo
    s_cbranch_scc0 L_out3
    s_sleep 8
    s_add_u32 s1, s1, 1
    s_cmp_lt_u32 s1, 65536
    s_cbranch_scc1 L_spin3
L_out3:
    s_waitcnt vmcnt(0)
    s_add_u32 s11, s6, 0
    buffer_load_dword v232, v14, s[56:59], s11 offen sc1
    s_add_u32 s11, s6, 8192
    buffer_load_dword v234, v14, s[56:59], s11 offen sc1
    s_add_u32 s11, s6, 32768
    buffer_load_dword v236, v14, s[56:59], s11 offen sc1
    s_add_u32 s11, s6, 40960
    buffer_load_dword v238, v14, s[56:59], s11 offen sc1
    s_add_u32 s11, s6, 65536
    buffer_load_dword v240, v14, s[56:59], s11 offen sc1
    s_add_u32 s11, s6, 73728
    buffer_load_dword v242, v14, s[56:59], s11 offen sc1
    s_add_u32 s11, s6, 98304
    buffer_load_dword v244, v14, s[56:59], s11 offen sc1
    s_add_u32 s11, s6, 106496
    buffer_load_dword v246, v14, s[56:59], s11 offen sc1
    s_waitcnt vmcnt(0)
    s_branch L_ret3
L_slow4:
    s_mov_b32 s1, 0
L_spin4:
    s_load_dwordx16 s[16:31], s[40:41], s13 glc
    s_load_dwordx16 s[68:83], s[40:41], s50 glc
    s_waitcnt lgkmcnt(0)
    s_mov_b64 vcc, s[16:17]
    s_or_b64 vcc, vcc, s[18:19]
    s_and_b64 s[16:17], s[16:17], s[18:19]
    s_or_b64 vcc, vcc, s[20:21]
    s_and_b64 s[16:17], s[16:17], s[20:21]
    s_or_b64 vcc, vcc, s[22:23]
    s_and_b64 s[16:17], s[16:17], s[22:23]
    s_or_b64 vcc, vcc, s[24:25]
    s_and_b64 s[16:17], s[16:17], s[24:25]
    s_or_b64 vcc, vcc, s[26:27]
    s_and_b64 s[16:17], s[16:17], s[26:27]
    s_or_b64 vcc, vcc, s[28:29]
    s_and_b64 s[16:17], s[16:17], s[28:29]
    s_or_b64 vcc, vcc, s[30:31]
    s_and_b64 s[16:17], s[16:17], s[30:31]
    s_or_b64 vcc, vcc, s[68:69]
    s_and_b64 s[16:17], s[16:17], s[68:69]
    s_or_b64 vcc, vcc, s[70:71]
    s_and_b64 s[16:17], s[16:17], s[70:71]
    s_or_b64 vcc, vcc, s[72:73]
    s_and_b64 s[16:17], s[16:17], s[72:73]
    s_or_b64 vcc, vcc, s[74:75]
    s_and_b64 s[16:17], s[16:17], s[74:75]
    s_or_b64 vcc, vcc, s[76:77]
    s_and_b64 s[16:17], s[16:17], s[76:77]
    s_or_b64 vcc, vcc, s[78:79]
    s_and_b64 s[16:17], s[16:17], s[78:79]
    s_or_b64 vcc, vcc, s[80:81]
    s_and_b64 s[16:17], s[16:17], s[80:81]
    s_or_b64 vcc, vcc, s[82:83]
    s_and_b64 s[16:17], s[16:17], s[82:83]
    s_or_b32 vcc_lo, vcc_lo, vcc_hi
    s_and_b32 s16, s16, s17
    s_xor_b32 vcc_lo, vcc_lo, s49
    s_xor_b32 s16, s16, s49
    s_or_b32 s16, s16, vcc_lo
    s_cbranch_scc0 L_out4
    s_sleep 8
    s_add_u32 s1, s1, 1
    s_cmp_lt_u32 s1, 65536
    s_cbranch_scc1 L_spin4
L_out4:
    s_branch L_ret4
L_slow5:
    s_mov_b32 s1, 0
L_spin5:
    s_sleep 4
    s_setprio 3
    buffer_load_dwordx4 v[120:123], v4, s[56:59], s14 offen offset:0 sc1
    buffer_load_dwordx4 v[124:127], v4, s[56:59], s15 offen offset:0 sc1
    buffer_load_dwordx4 v[128:131], v4, s[56:59], s14 offen offset:1024 sc1
    buffer_load_dwordx4 v[132:135], v4, s[56:59], s15 offen offset:1024 sc1
    s_setprio 0
    s_waitcnt vmcnt(0)
    v_xor_b32 v3, v121, v26
    v_bitop3_b32 v3, v3, v123, v26 bitop3:0xf6
    v_bitop3_b32 v3, v3, v125, v26 bitop3:0xf6
    v_bitop3_b32 v3, v3, v127, v26 bitop3:0xf6
    v_bitop3_b32 v3, v3, v129, v26 bitop3:0xf6
    v_bitop3_b32 v3, v3, v131, v26 bitop3:0xf6
    v_bitop3_b32 v3, v3, v133, v26 bitop3:0xf6
    v_bitop3_b32 v3, v3, v135, v26 bitop3:0xf6
    v_cmp_ne_u32 vcc, 0, v3
    s_nop 0
    s_cbranch_vccz L_ret5
    s_add_u32 s1, s1, 1
    s_cmp_lt_u32 s1, 65536
    s_cbranch_scc1 L_spin5
    s_branch L_ret5
L_slow6:
    s_mov_b32 s1, 0
L_spin6:
    s_add_u32 s50, s13, 128
    s_load_dwordx16 s[16:31], s[40:41], s13 glc
    s_load_dwordx16 s[68:83], s[40:41], s50 glc
    s_waitcnt lgkmcnt(0)
    s_mov_b64 vcc, s[16:17]
    s_or_b64 vcc, vcc, s[18:19]
    s_and_b64 s[16:17], s[16:17], s[18:19]
    s_or_b64 vcc, vcc, s[20:21]
    s_and_b64 s[16:17], s[16:17], s[20:21]
    s_or_b64 vcc, vcc, s[22:23]
    s_and_b64 s[16:17], s[16:17], s[22:23]
    s_or_b64 vcc, vcc, s[24:25]
    s_and_b64 s[16:17], s[16:17], s[24:25]
    s_or_b64 vcc, vcc, s[26:27]
    s_and_b64 s[16:17], s[16:17], s[26:27]
    s_or_b64 vcc, vcc, s[28:29]
    s_and_b64 s[16:17], s[16:17], s[28:29]
    s_or_b64 vcc, vcc, s[30:31]
    s_and_b64 s[16:17], s[16:17], s[30:31]
    s_or_b64 vcc, vcc, s[68:69]
    s_and_b64 s[16:17], s[16:17], s[68:69]
    s_or_b64 vcc, vcc, s[70:71]
    s_and_b64 s[16:17], s[16:17], s[70:71]
    s_or_b64 vcc, vcc, s[72:73]
    s_and_b64 s[16:17], s[16:17], s[72:73]
    s_or_b64 vcc, vcc, s[74:75]
    s_and_b64 s[16:17], s[16:17], s[74:75]
    s_or_b64 vcc, vcc, s[76:77]
    s_and_b64 s[16:17], s[16:17], s[76:77]
    s_or_b64 vcc, vcc, s[78:79]
    s_and_b64 s[16:17], s[16:17], s[78:79]
    s_or_b64 vcc, vcc, s[80:81]
    s_and_b64 s[16:17], s[16:17], s[80:81]
    s_or_b64 vcc, vcc, s[82:83]
    s_and_b64 s[16:17], s[16:17], s[82:83]
    s_or_b32 vcc_lo, vcc_lo, vcc_hi
    s_and_b32 s16, s16, s17
    s_xor_b32 vcc_lo, vcc_lo, s49
    s_xor_b32 s16, s16, s49
    s_or_b32 s16, s16, vcc_lo
    s_cbranch_scc0 L_out6
    s_sleep 8
    s_add_u32 s1, s1, 1
    s_cmp_lt_u32 s1, 65536
    s_cbranch_scc1 L_spin6
L_out6:
    s_branch L_ret6
L_slow7:
    s_mov_b32 s1, 0
L_spin7:
    s_add_u32 s50, s13, 128
    s_load_dwordx16 s[16:31], s[40:41], s13 glc
    s_load_dwordx16 s[68:83], s[40:41], s50 glc
    s_waitcnt lgkmcnt(0)
    s_mov_b64 vcc, s[16:17]
    s_or_b64 vcc, vcc, s[18:19]
    s_and_b64 s[16:17], s[16:17], s[18:19]
    s_or_b64 vcc, vcc, s[20:21]
    s_and_b64 s[16:17], s[16:17], s[20:21]
    s_or_b64 vcc, vcc, s[22:23]
    s_and_b64 s[16:17], s[16:17], s[22:23]
    s_or_b64 vcc, vcc, s[24:25]
    s_and_b64 s[16:17], s[16:17], s[24:25]
    s_or_b64 vcc, vcc, s[26:27]
    s_and_b64 s[16:17], s[16:17], s[26:27]
    s_or_b64 vcc, vcc, s[28:29]
    s_and_b64 s[16:17], s[16:17], s[28:29]
    s_or_b64 vcc, vcc, s[30:31]
    s_and_b64 s[16:17], s[16:17], s[30:31]
    s_or_b64 vcc, vcc, s[68:69]
    s_and_b64 s[16:17], s[16:17], s[68:69]
    s_or_b64 vcc, vcc, s[70:71]
    s_and_b64 s[16:17], s[16:17], s[70:71]
    s_or_b64 vcc, vcc, s[72:73]
    s_and_b64 s[16:17], s[16:17], s[72:73]
    s_or_b64 vcc, vcc, s[74:75]
    s_and_b64 s[16:17], s[16:17], s[74:75]
    s_or_b64 vcc, vcc, s[76:77]
    s_and_b64 s[16:17], s[16:17], s[76:77]
    s_or_b64 vcc, vcc, s[78:79]
    s_and_b64 s[16:17], s[16:17], s[78:79]
    s_or_b64 vcc, vcc, s[80:81]
    s_and_b64 s[16:17], s[16:17], s[80:81]
    s_or_b64 vcc, vcc, s[82:83]
    s_and_b64 s[16:17], s[16:17], s[82:83]
    s_or_b32 vcc_lo, vcc_lo, vcc_hi
    s_and_b32 s16, s16, s17
    s_xor_b32 vcc_lo, vcc_lo, s49
    s_xor_b32 s16, s16, s49
    s_or_b32 s16, s16, vcc_lo
    s_cbranch_scc0 L_out7
    s_sleep 8
    s_add_u32 s1, s1, 1
    s_cmp_lt_u32 s1, 65536
    s_cbranch_scc1 L_spin7
L_out7:
    s_branch L_ret7
L_code_end:
.section .rodata,"a"
.p2align 6
.amdhsa_kernel parallel_sum__ssm_conv_s4d__dense_activation_relu__prompt_kernel
  .amdhsa_next_free_vgpr 256
  .amdhsa_next_free_sgpr 102
  .amdhsa_accum_offset 256
  .amdhsa_group_segment_fixed_size 0
  .amdhsa_kernarg_size 104
  .amdhsa_user_sgpr_count 2
  .amdhsa_user_sgpr_kernarg_segment_ptr 1
  .amdhsa_system_sgpr_workgroup_id_x 1
.end_amdhsa_kernel
```
